```python
import torch

def _softmax(x, axis=-1):
    return torch.softmax(x, dim=axis)
def _gelu(x):
    return torch.nn.functional.gelu(x, approximate="tanh")
def _silu(x):
    return torch.nn.functional.silu(x)
def _sigmoid(x):
    return torch.sigmoid(x)
def _layernorm(x, axis=-1, eps=1e-5):
    m = x.mean(dim=axis, keepdim=True)
    v = x.var(dim=axis, keepdim=True, unbiased=False)
    return (x - m) / torch.sqrt(v + eps)
def _scatter_add(tgt, idx, src, axis=0):
    return tgt.clone().index_add_(axis, idx, src)
def _segment_sum(src, seg, n):
    out = torch.zeros((n,) + src.shape[1:], dtype=src.dtype)
    return out.index_add_(0, seg, src)
def _pad(x, pw):
    flat = tuple(v for pair in reversed(pw) for v in pair)
    return torch.nn.functional.pad(x, flat)

kernel_name = 'standalone__weight_only_int_quip_2__prompt'

def setup_inputs():

    _w = (lambda a: (lambda t: t.to(torch.bfloat16) if t.is_floating_point() else t)(torch.as_tensor(a)))
    B, S, D, F = 1, 2048, 576, 4608
    nbits = max(2, min(4, int(3)))
    G = 32 if 32 > 0 else D
    D = (D // G) * G
    ng = D // G
    qmax = 1 << nbits
    qw = torch.randint(0, qmax, (D, F)).to(torch.int32)
    zp = torch.randint(0, qmax, (ng, F)).to(float)
    sc = torch.abs((lambda *s: torch.randn(*s, dtype=torch.bfloat16) * 0.05)(ng, F)).to(float) * 0.1 + 0.02
    return {
        "x": _w((lambda *s: torch.randn(*s, dtype=torch.bfloat16) * 0.05)(B, S, D)),
        "qw": _w(qw),
        "scales": _w(sc),
        "zeros": _w(zp),
    }

def reference(x, qw, scales, zeros):
    B, S, D = x.shape
    ng, F = scales.shape
    G = D // ng
    s = (lambda x, n, axis: torch.repeat_interleave(x, n, dim=axis))(scales, G, axis=0)
    z = (lambda x, n, axis: torch.repeat_interleave(x, n, dim=axis))(zeros, G, axis=0)
    w = ((lambda x, dt: x.to(dt))(qw, x.dtype) - z) * s
    return torch.einsum("bsd,df->bsf", x, w)
```

```asm
; @launch grid=(256,1,1) block=(512,1,1) lds=158208
.amdgcn_target "amdgcn-amd-amdhsa--gfx950"
.text
.globl standalone__weight_only_int_quip_2__prompt_kernel
.p2align 8
.type standalone__weight_only_int_quip_2__prompt_kernel,@function
standalone__weight_only_int_quip_2__prompt_kernel:
    s_load_dwordx4 s[4:7], s[0:1], 0
    s_load_dwordx4 s[8:11], s[0:1], 16
    s_load_dwordx2 s[12:13], s[0:1], 32
    s_cmp_ge_u32 s2, 256
    s_cbranch_scc1 L_done
    s_and_b32 s36, s2, 7
    s_lshr_b32 s37, s2, 3
    s_and_b32 s38, s37, 3
    s_lshr_b32 s37, s37, 2
    v_lshrrev_b32 v2, 6, v0
    v_and_b32 v1, 63, v0
    v_readfirstlane_b32 s48, v2
    s_mul_i32 s39, s36, 576
    s_lshl_b32 s40, s38, 7
    s_add_u32 s40, s40, s39
    s_lshl_b32 s41, s38, 4
    s_add_u32 s41, s41, s39
    s_add_u32 s41, s41, 512
    s_lshl_b32 s42, s37, 8
    s_and_b32 s49, s48, 3
    s_mov_b32 s43, s37
    s_mul_i32 s44, s43, 103
    s_lshr_b32 s44, s44, 9
    s_mul_i32 s44, s44, 5
    s_sub_u32 s43, s43, s44
    s_mul_i32 s43, s43, 2
    v_and_b32 v200, 15, v1
    v_lshrrev_b32 v201, 4, v1
    v_lshl_add_u32 v67, v200, 3, s40
    v_add_u32 v68, s41, v200
    s_lshl_b32 s51, s43, 1
    s_cmp_ge_u32 s48, 4
    s_cbranch_scc1 L_prod
    s_mul_i32 s50, s2, 72
    s_mul_i32 s52, s49, 18
    s_add_u32 s50, s50, s52
    v_add_u32 v104, s50, v1
    v_lshlrev_b32 v104, 7, v104
    v_mov_b32 v105, 0x7ff00000
    v_cmp_lt_u32 vcc, 17, v1
    s_lshl_b32 s50, s49, 2
    s_add_u32 s50, s50, 2
    v_cndmask_b32 v104, v104, v105, vcc
    v_add_u32 v62, s50, v201
    v_add_u32 v63, s51, v62
    v_subrev_u32 v64, 18, v63
    v_min_u32 v63, v63, v64
    v_mul_u32_u24 v63, 9216, v63
    v_lshl_add_u32 v69, v67, 1, v63
    v_lshl_add_u32 v70, v68, 1, v63
    v_lshrrev_b32 v202, 3, v1
    v_and_b32 v203, 7, v1
    s_lshl_b32 s58, s49, 6
    s_add_u32 s50, s58, s42
    v_xor_b32 v204, v203, v202
    v_add_u32 v205, s50, v202
    v_mul_u32_u24 v205, 1152, v205
    v_lshl_add_u32 v10, v204, 4, v205
    s_lshl_b32 s58, s49, 13
    s_lshl_b32 s55, s43, 7
    s_waitcnt lgkmcnt(0)
    s_mov_b32 s16, s4
    s_and_b32 s17, s5, 0xffff
    s_mov_b32 s18, 2359296
    s_mov_b32 s19, 0x20000
    buffer_load_dword v107, v104, s[16:19], 0 offen
    s_mov_b32 s24, s8
    s_and_b32 s25, s9, 0xffff
    s_mov_b32 s26, 165888
    s_mov_b32 s27, 0x20000
    s_mov_b32 s28, s10
    s_and_b32 s29, s11, 0xffff
    s_mov_b32 s30, 165888
    s_mov_b32 s31, 0x20000
    buffer_load_dwordx4 v[112:115], v69, s[24:27], 0 offen
    buffer_load_dwordx4 v[116:119], v69, s[28:31], 0 offen
    buffer_load_ushort v120, v70, s[24:27], 0 offen
    buffer_load_ushort v121, v70, s[28:31], 0 offen
    v_add_u32 v11, 8192, v10
    v_add_u32 v12, 16384, v10
    v_add_u32 v13, 24576, v10
    v_add_u32 v14, 36864, v10
    v_add_u32 v15, 45056, v10
    v_add_u32 v16, 53248, v10
    v_add_u32 v17, 61440, v10
    s_mov_b32 s32, s12
    s_and_b32 s33, s13, 0xffff
    s_mov_b32 s34, 18874368
    s_mov_b32 s35, 0x20000
    v_lshl_add_u32 v73, v62, 4, v200
    v_mul_u32_u24 v73, 80, v73
    v_add_u32 v73, 135168, v73
    s_lshl_b32 s50, s49, 6
    v_add_u32 v2, s50, v200
    v_and_b32 v3, 7, v200
    v_xor_b32 v3, v3, v201
    v_lshlrev_b32 v3, 4, v3
    v_lshl_add_u32 v2, v2, 7, v3
    v_xor_b32 v3, 64, v2
    v_add_u32 v4, 0x10000, v2
    v_add_u32 v5, 0x10000, v3
    v_lshlrev_b32 v6, 4, v1
    v_add_u32 v6, 98304, v6
    s_movk_i32 s52, 9216
    s_add_u32 s50, s50, s42
    v_lshl_add_u32 v7, v201, 2, s50
    v_mul_lo_u32 v7, v7, s52
    v_lshl_add_u32 v7, v67, 1, v7
    v_add_u32 v8, s50, v200
    v_mul_lo_u32 v8, v8, s52
    v_lshl_add_u32 v9, v201, 2, s41
    v_lshl_add_u32 v8, v9, 1, v8
    s_waitcnt vmcnt(0)
    v_lshlrev_b32 v144, 16, v112
    v_and_b32 v145, 0xffff0000, v112
    v_lshlrev_b32 v152, 16, v116
    v_and_b32 v153, 0xffff0000, v116
    v_lshlrev_b32 v146, 16, v113
    v_and_b32 v147, 0xffff0000, v113
    v_lshlrev_b32 v154, 16, v117
    v_and_b32 v155, 0xffff0000, v117
    v_lshlrev_b32 v148, 16, v114
    v_and_b32 v149, 0xffff0000, v114
    v_lshlrev_b32 v156, 16, v118
    v_and_b32 v157, 0xffff0000, v118
    v_lshlrev_b32 v150, 16, v115
    v_and_b32 v151, 0xffff0000, v115
    v_lshlrev_b32 v158, 16, v119
    v_and_b32 v159, 0xffff0000, v119
    v_lshlrev_b32 v160, 16, v120
    v_lshlrev_b32 v161, 16, v121
    v_mul_f32_e64 v152, -v152, v144
    v_mul_f32_e64 v153, -v153, v145
    v_mul_f32_e64 v154, -v154, v146
    v_mul_f32_e64 v155, -v155, v147
    v_mul_f32_e64 v156, -v156, v148
    v_mul_f32_e64 v157, -v157, v149
    v_mul_f32_e64 v158, -v158, v150
    v_mul_f32_e64 v159, -v159, v151
    v_mul_f32_e64 v161, -v161, v160
    v_mul_f32 v144, 0x4b800000, v144
    v_mul_f32 v145, 0x4b800000, v145
    v_mul_f32 v146, 0x4b800000, v146
    v_mul_f32 v147, 0x4b800000, v147
    v_mul_f32 v148, 0x4b800000, v148
    v_mul_f32 v149, 0x4b800000, v149
    v_mul_f32 v150, 0x4b800000, v150
    v_mul_f32 v151, 0x4b800000, v151
    v_mul_f32 v160, 0x4b800000, v160
    ds_write_b128 v73, v[144:147] offset:0
    ds_write_b128 v73, v[148:151] offset:16
    ds_write_b128 v73, v[152:155] offset:32
    ds_write_b128 v73, v[156:159] offset:48
    ds_write_b64 v73, v[160:161] offset:64
    s_add_u32 m0, s58, 0
    s_nop 0
    buffer_load_dwordx4 v10, s[16:19], s55 offen offset:0 lds
    buffer_load_dwordx4 v11, s[16:19], s55 offen offset:1024 lds
    buffer_load_dwordx4 v12, s[16:19], s55 offen offset:2048 lds
    buffer_load_dwordx4 v13, s[16:19], s55 offen offset:3072 lds
    s_add_u32 m0, s58, 4096
    s_nop 0
    buffer_load_dwordx4 v14, s[16:19], s55 offen offset:0 lds
    buffer_load_dwordx4 v15, s[16:19], s55 offen offset:1024 lds
    buffer_load_dwordx4 v16, s[16:19], s55 offen offset:2048 lds
    buffer_load_dwordx4 v17, s[16:19], s55 offen offset:3072 lds
    s_add_u32 s55, s55, 128
    s_cmp_ge_u32 s55, 1152
    s_cselect_b32 s55, 0, s55
    s_add_u32 m0, s58, 32768
    s_nop 0
    buffer_load_dwordx4 v10, s[16:19], s55 offen offset:0 lds
    buffer_load_dwordx4 v11, s[16:19], s55 offen offset:1024 lds
    buffer_load_dwordx4 v12, s[16:19], s55 offen offset:2048 lds
    buffer_load_dwordx4 v13, s[16:19], s55 offen offset:3072 lds
    s_add_u32 m0, s58, 36864
    s_nop 0
    buffer_load_dwordx4 v14, s[16:19], s55 offen offset:0 lds
    buffer_load_dwordx4 v15, s[16:19], s55 offen offset:1024 lds
    buffer_load_dwordx4 v16, s[16:19], s55 offen offset:2048 lds
    buffer_load_dwordx4 v17, s[16:19], s55 offen offset:3072 lds
    s_add_u32 s55, s55, 128
    s_cmp_ge_u32 s55, 1152
    s_cselect_b32 s55, 0, s55
    s_waitcnt vmcnt(8)
    s_waitcnt lgkmcnt(0)
    s_barrier
    ds_read_b128 v[52:55], v6 offset:0
    ds_read_b128 v[20:23], v2 offset:0
    ds_read_b128 v[24:27], v2 offset:2048
    ds_read_b128 v[28:31], v2 offset:4096
    ds_read_b128 v[32:35], v2 offset:6144
    ds_read_b128 v[56:59], v6 offset:1024
    ds_read_b128 v[60:63], v6 offset:2048
    ds_read_b128 v[64:67], v6 offset:3072
    ds_read_b128 v[68:71], v6 offset:4096
    ds_read_b128 v[72:75], v6 offset:5120
    ds_read_b128 v[76:79], v6 offset:6144
    ds_read_b128 v[80:83], v6 offset:7168
    ds_read_b128 v[84:87], v6 offset:8192
    s_waitcnt lgkmcnt(8)
    v_mfma_f32_16x16x32_bf16 v[112:115], v[20:23], v[52:55], 0
    ds_read_b128 v[36:39], v3 offset:0
    v_mfma_f32_16x16x32_bf16 v[148:151], v[24:27], v[52:55], 0
    ds_read_b128 v[40:43], v3 offset:2048
    v_mfma_f32_16x16x32_bf16 v[184:187], v[28:31], v[52:55], 0
    ds_read_b128 v[44:47], v3 offset:4096
    v_mfma_f32_16x16x32_bf16 v[220:223], v[32:35], v[52:55], 0
    ds_read_b128 v[48:51], v3 offset:6144
    s_waitcnt lgkmcnt(11)
    v_mfma_f32_16x16x32_bf16 v[116:119], v[20:23], v[56:59], 0
    ds_read_b128 v[52:55], v6 offset:9216
    v_mfma_f32_16x16x32_bf16 v[152:155], v[24:27], v[56:59], 0
    v_mfma_f32_16x16x32_bf16 v[188:191], v[28:31], v[56:59], 0
    v_mfma_f32_16x16x32_bf16 v[224:227], v[32:35], v[56:59], 0
    ds_read_b128 v[56:59], v6 offset:10240
    s_waitcnt lgkmcnt(12)
    v_mfma_f32_16x16x32_bf16 v[120:123], v[20:23], v[60:63], 0
    s_add_u32 m0, s58, 65536
    s_nop 0
    buffer_load_dwordx4 v10, s[16:19], s55 offen offset:0 lds
    v_mfma_f32_16x16x32_bf16 v[156:159], v[24:27], v[60:63], 0
    v_mfma_f32_16x16x32_bf16 v[192:195], v[28:31], v[60:63], 0
    v_mfma_f32_16x16x32_bf16 v[228:231], v[32:35], v[60:63], 0
    ds_read_b128 v[60:63], v6 offset:11264
    s_waitcnt lgkmcnt(12)
    v_mfma_f32_16x16x32_bf16 v[124:127], v[20:23], v[64:67], 0
    v_mfma_f32_16x16x32_bf16 v[160:163], v[24:27], v[64:67], 0
    v_mfma_f32_16x16x32_bf16 v[196:199], v[28:31], v[64:67], 0
    v_mfma_f32_16x16x32_bf16 v[232:235], v[32:35], v[64:67], 0
    ds_read_b128 v[64:67], v6 offset:12288
    s_waitcnt lgkmcnt(12)
    v_mfma_f32_16x16x32_bf16 v[128:131], v[20:23], v[68:71], 0
    buffer_load_dwordx4 v11, s[16:19], s55 offen offset:1024 lds
    v_mfma_f32_16x16x32_bf16 v[164:167], v[24:27], v[68:71], 0
    v_mfma_f32_16x16x32_bf16 v[200:203], v[28:31], v[68:71], 0
    v_mfma_f32_16x16x32_bf16 v[236:239], v[32:35], v[68:71], 0
    ds_read_b128 v[68:71], v6 offset:13312
    s_waitcnt lgkmcnt(12)
    v_mfma_f32_16x16x32_bf16 v[132:135], v[20:23], v[72:75], 0
    v_mfma_f32_16x16x32_bf16 v[168:171], v[24:27], v[72:75], 0
    v_mfma_f32_16x16x32_bf16 v[204:207], v[28:31], v[72:75], 0
    v_mfma_f32_16x16x32_bf16 v[240:243], v[32:35], v[72:75], 0
    ds_read_b128 v[72:75], v6 offset:14336
    s_waitcnt lgkmcnt(12)
    v_mfma_f32_16x16x32_bf16 v[136:139], v[20:23], v[76:79], 0
    buffer_load_dwordx4 v12, s[16:19], s55 offen offset:2048 lds
    v_mfma_f32_16x16x32_bf16 v[172:175], v[24:27], v[76:79], 0
    v_mfma_f32_16x16x32_bf16 v[208:211], v[28:31], v[76:79], 0
    v_mfma_f32_16x16x32_bf16 v[244:247], v[32:35], v[76:79], 0
    ds_read_b128 v[76:79], v6 offset:15360
    s_waitcnt lgkmcnt(12)
    v_mfma_f32_16x16x32_bf16 v[140:143], v[20:23], v[80:83], 0
    v_mfma_f32_16x16x32_bf16 v[176:179], v[24:27], v[80:83], 0
    v_mfma_f32_16x16x32_bf16 v[212:215], v[28:31], v[80:83], 0
    v_mfma_f32_16x16x32_bf16 v[248:251], v[32:35], v[80:83], 0
    ds_read_b128 v[80:83], v6 offset:16384
    s_waitcnt lgkmcnt(12)
    v_mfma_f32_16x16x32_bf16 v[144:147], v[84:87], v[20:23], 0
    buffer_load_dwordx4 v13, s[16:19], s55 offen offset:3072 lds
    v_mfma_f32_16x16x32_bf16 v[180:183], v[84:87], v[24:27], 0
    v_mfma_f32_16x16x32_bf16 v[216:219], v[84:87], v[28:31], 0
    v_mfma_f32_16x16x32_bf16 v[252:255], v[84:87], v[32:35], 0
    ds_read_b128 v[84:87], v6 offset:17408
    s_waitcnt lgkmcnt(8)
    v_mfma_f32_16x16x32_bf16 v[112:115], v[36:39], v[52:55], v[112:115]
    v_mfma_f32_16x16x32_bf16 v[148:151], v[40:43], v[52:55], v[148:151]
    v_mfma_f32_16x16x32_bf16 v[184:187], v[44:47], v[52:55], v[184:187]
    v_mfma_f32_16x16x32_bf16 v[220:223], v[48:51], v[52:55], v[220:223]
    s_waitcnt lgkmcnt(7)
    v_mfma_f32_16x16x32_bf16 v[116:119], v[36:39], v[56:59], v[116:119]
    s_add_u32 m0, s58, 69632
    s_nop 0
    buffer_load_dwordx4 v14, s[16:19], s55 offen offset:0 lds
    v_mfma_f32_16x16x32_bf16 v[152:155], v[40:43], v[56:59], v[152:155]
    v_mfma_f32_16x16x32_bf16 v[188:191], v[44:47], v[56:59], v[188:191]
    v_mfma_f32_16x16x32_bf16 v[224:227], v[48:51], v[56:59], v[224:227]
    s_waitcnt vmcnt(5)
    s_waitcnt lgkmcnt(0)
    s_barrier
    v_mfma_f32_16x16x32_bf16 v[120:123], v[36:39], v[60:63], v[120:123]
    ds_read_b128 v[20:23], v2 offset:32768
    v_mfma_f32_16x16x32_bf16 v[156:159], v[40:43], v[60:63], v[156:159]
    ds_read_b128 v[24:27], v2 offset:34816
    v_mfma_f32_16x16x32_bf16 v[192:195], v[44:47], v[60:63], v[192:195]
    ds_read_b128 v[28:31], v2 offset:36864
    v_mfma_f32_16x16x32_bf16 v[228:231], v[48:51], v[60:63], v[228:231]
    ds_read_b128 v[32:35], v2 offset:38912
    v_mfma_f32_16x16x32_bf16 v[124:127], v[36:39], v[64:67], v[124:127]
    ds_read_b128 v[52:55], v6 offset:18432
    v_mfma_f32_16x16x32_bf16 v[160:163], v[40:43], v[64:67], v[160:163]
    ds_read_b128 v[56:59], v6 offset:19456
    v_mfma_f32_16x16x32_bf16 v[196:199], v[44:47], v[64:67], v[196:199]
    ds_read_b128 v[60:63], v6 offset:20480
    v_mfma_f32_16x16x32_bf16 v[232:235], v[48:51], v[64:67], v[232:235]
    ds_read_b128 v[64:67], v6 offset:21504
    v_mfma_f32_16x16x32_bf16 v[128:131], v[36:39], v[68:71], v[128:131]
    buffer_load_dwordx4 v15, s[16:19], s55 offen offset:1024 lds
    v_mfma_f32_16x16x32_bf16 v[164:167], v[40:43], v[68:71], v[164:167]
    v_mfma_f32_16x16x32_bf16 v[200:203], v[44:47], v[68:71], v[200:203]
    v_mfma_f32_16x16x32_bf16 v[236:239], v[48:51], v[68:71], v[236:239]
    ds_read_b128 v[68:71], v6 offset:22528
    v_mfma_f32_16x16x32_bf16 v[132:135], v[36:39], v[72:75], v[132:135]
    v_mfma_f32_16x16x32_bf16 v[168:171], v[40:43], v[72:75], v[168:171]
    v_mfma_f32_16x16x32_bf16 v[204:207], v[44:47], v[72:75], v[204:207]
    v_mfma_f32_16x16x32_bf16 v[240:243], v[48:51], v[72:75], v[240:243]
    ds_read_b128 v[72:75], v6 offset:23552
    v_mfma_f32_16x16x32_bf16 v[136:139], v[36:39], v[76:79], v[136:139]
    buffer_load_dwordx4 v16, s[16:19], s55 offen offset:2048 lds
    v_mfma_f32_16x16x32_bf16 v[172:175], v[40:43], v[76:79], v[172:175]
    v_mfma_f32_16x16x32_bf16 v[208:211], v[44:47], v[76:79], v[208:211]
    v_mfma_f32_16x16x32_bf16 v[244:247], v[48:51], v[76:79], v[244:247]
    ds_read_b128 v[76:79], v6 offset:24576
    v_mfma_f32_16x16x32_bf16 v[140:143], v[36:39], v[80:83], v[140:143]
    v_mfma_f32_16x16x32_bf16 v[176:179], v[40:43], v[80:83], v[176:179]
    v_mfma_f32_16x16x32_bf16 v[212:215], v[44:47], v[80:83], v[212:215]
    v_mfma_f32_16x16x32_bf16 v[248:251], v[48:51], v[80:83], v[248:251]
    ds_read_b128 v[80:83], v6 offset:25600
    v_mfma_f32_16x16x32_bf16 v[144:147], v[84:87], v[36:39], v[144:147]
    buffer_load_dwordx4 v17, s[16:19], s55 offen offset:3072 lds
    s_add_u32 s55, s55, 128
    s_cmp_ge_u32 s55, 1152
    s_cselect_b32 s55, 0, s55
    v_mfma_f32_16x16x32_bf16 v[180:183], v[84:87], v[40:43], v[180:183]
    v_mfma_f32_16x16x32_bf16 v[216:219], v[84:87], v[44:47], v[216:219]
    v_mfma_f32_16x16x32_bf16 v[252:255], v[84:87], v[48:51], v[252:255]
    ds_read_b128 v[84:87], v6 offset:26624
    s_waitcnt lgkmcnt(8)
    v_mfma_f32_16x16x32_bf16 v[112:115], v[20:23], v[52:55], v[112:115]
    ds_read_b128 v[36:39], v3 offset:32768
    v_mfma_f32_16x16x32_bf16 v[148:151], v[24:27], v[52:55], v[148:151]
    ds_read_b128 v[40:43], v3 offset:34816
    v_mfma_f32_16x16x32_bf16 v[184:187], v[28:31], v[52:55], v[184:187]
    ds_read_b128 v[44:47], v3 offset:36864
    v_mfma_f32_16x16x32_bf16 v[220:223], v[32:35], v[52:55], v[220:223]
    ds_read_b128 v[48:51], v3 offset:38912
    s_waitcnt lgkmcnt(11)
    v_mfma_f32_16x16x32_bf16 v[116:119], v[20:23], v[56:59], v[116:119]
    ds_read_b128 v[52:55], v6 offset:27648
    v_mfma_f32_16x16x32_bf16 v[152:155], v[24:27], v[56:59], v[152:155]
    s_add_u32 m0, s58, 0
    s_nop 0
    buffer_load_dwordx4 v10, s[16:19], s55 offen offset:0 lds
    v_mfma_f32_16x16x32_bf16 v[188:191], v[28:31], v[56:59], v[188:191]
    v_mfma_f32_16x16x32_bf16 v[224:227], v[32:35], v[56:59], v[224:227]
    ds_read_b128 v[56:59], v6 offset:28672
    s_waitcnt lgkmcnt(12)
    v_mfma_f32_16x16x32_bf16 v[120:123], v[20:23], v[60:63], v[120:123]
    v_mfma_f32_16x16x32_bf16 v[156:159], v[24:27], v[60:63], v[156:159]
    v_mfma_f32_16x16x32_bf16 v[192:195], v[28:31], v[60:63], v[192:195]
    v_mfma_f32_16x16x32_bf16 v[228:231], v[32:35], v[60:63], v[228:231]
    ds_read_b128 v[60:63], v6 offset:29696
    s_waitcnt lgkmcnt(12)
    v_mfma_f32_16x16x32_bf16 v[124:127], v[20:23], v[64:67], v[124:127]
    v_mfma_f32_16x16x32_bf16 v[160:163], v[24:27], v[64:67], v[160:163]
    buffer_load_dwordx4 v11, s[16:19], s55 offen offset:1024 lds
    v_mfma_f32_16x16x32_bf16 v[196:199], v[28:31], v[64:67], v[196:199]
    v_mfma_f32_16x16x32_bf16 v[232:235], v[32:35], v[64:67], v[232:235]
    ds_read_b128 v[64:67], v6 offset:30720
    s_waitcnt lgkmcnt(12)
    v_mfma_f32_16x16x32_bf16 v[128:131], v[20:23], v[68:71], v[128:131]
    v_mfma_f32_16x16x32_bf16 v[164:167], v[24:27], v[68:71], v[164:167]
    v_mfma_f32_16x16x32_bf16 v[200:203], v[28:31], v[68:71], v[200:203]
    v_mfma_f32_16x16x32_bf16 v[236:239], v[32:35], v[68:71], v[236:239]
    ds_read_b128 v[68:71], v6 offset:31744
    s_waitcnt lgkmcnt(12)
    v_mfma_f32_16x16x32_bf16 v[132:135], v[20:23], v[72:75], v[132:135]
    v_mfma_f32_16x16x32_bf16 v[168:171], v[24:27], v[72:75], v[168:171]
    buffer_load_dwordx4 v12, s[16:19], s55 offen offset:2048 lds
    v_mfma_f32_16x16x32_bf16 v[204:207], v[28:31], v[72:75], v[204:207]
    v_mfma_f32_16x16x32_bf16 v[240:243], v[32:35], v[72:75], v[240:243]
    ds_read_b128 v[72:75], v6 offset:32768
    s_waitcnt lgkmcnt(12)
    v_mfma_f32_16x16x32_bf16 v[136:139], v[20:23], v[76:79], v[136:139]
    v_mfma_f32_16x16x32_bf16 v[172:175], v[24:27], v[76:79], v[172:175]
    v_mfma_f32_16x16x32_bf16 v[208:211], v[28:31], v[76:79], v[208:211]
    v_mfma_f32_16x16x32_bf16 v[244:247], v[32:35], v[76:79], v[244:247]
    ds_read_b128 v[76:79], v6 offset:33792
    s_waitcnt lgkmcnt(12)
    v_mfma_f32_16x16x32_bf16 v[140:143], v[20:23], v[80:83], v[140:143]
    v_mfma_f32_16x16x32_bf16 v[176:179], v[24:27], v[80:83], v[176:179]
    buffer_load_dwordx4 v13, s[16:19], s55 offen offset:3072 lds
    v_mfma_f32_16x16x32_bf16 v[212:215], v[28:31], v[80:83], v[212:215]
    v_mfma_f32_16x16x32_bf16 v[248:251], v[32:35], v[80:83], v[248:251]
    ds_read_b128 v[80:83], v6 offset:34816
    s_waitcnt lgkmcnt(12)
    v_mfma_f32_16x16x32_bf16 v[144:147], v[84:87], v[20:23], v[144:147]
    v_mfma_f32_16x16x32_bf16 v[180:183], v[84:87], v[24:27], v[180:183]
    v_mfma_f32_16x16x32_bf16 v[216:219], v[84:87], v[28:31], v[216:219]
    v_mfma_f32_16x16x32_bf16 v[252:255], v[84:87], v[32:35], v[252:255]
    ds_read_b128 v[84:87], v6 offset:35840
    s_waitcnt lgkmcnt(8)
    v_mfma_f32_16x16x32_bf16 v[112:115], v[36:39], v[52:55], v[112:115]
    v_mfma_f32_16x16x32_bf16 v[148:151], v[40:43], v[52:55], v[148:151]
    s_add_u32 m0, s58, 4096
    s_nop 0
    buffer_load_dwordx4 v14, s[16:19], s55 offen offset:0 lds
    v_mfma_f32_16x16x32_bf16 v[184:187], v[44:47], v[52:55], v[184:187]
    v_mfma_f32_16x16x32_bf16 v[220:223], v[48:51], v[52:55], v[220:223]
    s_waitcnt lgkmcnt(7)
    v_mfma_f32_16x16x32_bf16 v[116:119], v[36:39], v[56:59], v[116:119]
    v_mfma_f32_16x16x32_bf16 v[152:155], v[40:43], v[56:59], v[152:155]
    v_mfma_f32_16x16x32_bf16 v[188:191], v[44:47], v[56:59], v[188:191]
    v_mfma_f32_16x16x32_bf16 v[224:227], v[48:51], v[56:59], v[224:227]
    s_waitcnt vmcnt(5)
    s_waitcnt lgkmcnt(0)
    s_barrier
    v_mfma_f32_16x16x32_bf16 v[120:123], v[36:39], v[60:63], v[120:123]
    ds_read_b128 v[20:23], v4 offset:0
    v_mfma_f32_16x16x32_bf16 v[156:159], v[40:43], v[60:63], v[156:159]
    ds_read_b128 v[24:27], v4 offset:2048
    v_mfma_f32_16x16x32_bf16 v[192:195], v[44:47], v[60:63], v[192:195]
    ds_read_b128 v[28:31], v4 offset:4096
    v_mfma_f32_16x16x32_bf16 v[228:231], v[48:51], v[60:63], v[228:231]
    ds_read_b128 v[32:35], v4 offset:6144
    v_mfma_f32_16x16x32_bf16 v[124:127], v[36:39], v[64:67], v[124:127]
    ds_read_b128 v[52:55], v6 offset:0
    v_mfma_f32_16x16x32_bf16 v[160:163], v[40:43], v[64:67], v[160:163]
    ds_read_b128 v[56:59], v6 offset:1024
    v_mfma_f32_16x16x32_bf16 v[196:199], v[44:47], v[64:67], v[196:199]
    ds_read_b128 v[60:63], v6 offset:2048
    v_mfma_f32_16x16x32_bf16 v[232:235], v[48:51], v[64:67], v[232:235]
    ds_read_b128 v[64:67], v6 offset:3072
    v_mfma_f32_16x16x32_bf16 v[128:131], v[36:39], v[68:71], v[128:131]
    buffer_load_dwordx4 v15, s[16:19], s55 offen offset:1024 lds
    v_mfma_f32_16x16x32_bf16 v[164:167], v[40:43], v[68:71], v[164:167]
    v_mfma_f32_16x16x32_bf16 v[200:203], v[44:47], v[68:71], v[200:203]
    v_mfma_f32_16x16x32_bf16 v[236:239], v[48:51], v[68:71], v[236:239]
    ds_read_b128 v[68:71], v6 offset:4096
    v_mfma_f32_16x16x32_bf16 v[132:135], v[36:39], v[72:75], v[132:135]
    v_mfma_f32_16x16x32_bf16 v[168:171], v[40:43], v[72:75], v[168:171]
    v_mfma_f32_16x16x32_bf16 v[204:207], v[44:47], v[72:75], v[204:207]
    v_mfma_f32_16x16x32_bf16 v[240:243], v[48:51], v[72:75], v[240:243]
    ds_read_b128 v[72:75], v6 offset:5120
    v_mfma_f32_16x16x32_bf16 v[136:139], v[36:39], v[76:79], v[136:139]
    buffer_load_dwordx4 v16, s[16:19], s55 offen offset:2048 lds
    v_mfma_f32_16x16x32_bf16 v[172:175], v[40:43], v[76:79], v[172:175]
    v_mfma_f32_16x16x32_bf16 v[208:211], v[44:47], v[76:79], v[208:211]
    v_mfma_f32_16x16x32_bf16 v[244:247], v[48:51], v[76:79], v[244:247]
    ds_read_b128 v[76:79], v6 offset:6144
    v_mfma_f32_16x16x32_bf16 v[140:143], v[36:39], v[80:83], v[140:143]
    v_mfma_f32_16x16x32_bf16 v[176:179], v[40:43], v[80:83], v[176:179]
    v_mfma_f32_16x16x32_bf16 v[212:215], v[44:47], v[80:83], v[212:215]
    v_mfma_f32_16x16x32_bf16 v[248:251], v[48:51], v[80:83], v[248:251]
    ds_read_b128 v[80:83], v6 offset:7168
    v_mfma_f32_16x16x32_bf16 v[144:147], v[84:87], v[36:39], v[144:147]
    buffer_load_dwordx4 v17, s[16:19], s55 offen offset:3072 lds
    s_add_u32 s55, s55, 128
    s_cmp_ge_u32 s55, 1152
    s_cselect_b32 s55, 0, s55
    v_mfma_f32_16x16x32_bf16 v[180:183], v[84:87], v[40:43], v[180:183]
    v_mfma_f32_16x16x32_bf16 v[216:219], v[84:87], v[44:47], v[216:219]
    v_mfma_f32_16x16x32_bf16 v[252:255], v[84:87], v[48:51], v[252:255]
    ds_read_b128 v[84:87], v6 offset:8192
    s_waitcnt lgkmcnt(8)
    v_mfma_f32_16x16x32_bf16 v[112:115], v[20:23], v[52:55], v[112:115]
    ds_read_b128 v[36:39], v5 offset:0
    v_mfma_f32_16x16x32_bf16 v[148:151], v[24:27], v[52:55], v[148:151]
    ds_read_b128 v[40:43], v5 offset:2048
    v_mfma_f32_16x16x32_bf16 v[184:187], v[28:31], v[52:55], v[184:187]
    ds_read_b128 v[44:47], v5 offset:4096
    v_mfma_f32_16x16x32_bf16 v[220:223], v[32:35], v[52:55], v[220:223]
    ds_read_b128 v[48:51], v5 offset:6144
    s_waitcnt lgkmcnt(11)
    v_mfma_f32_16x16x32_bf16 v[116:119], v[20:23], v[56:59], v[116:119]
    ds_read_b128 v[52:55], v6 offset:9216
    v_mfma_f32_16x16x32_bf16 v[152:155], v[24:27], v[56:59], v[152:155]
    s_add_u32 m0, s58, 32768
    s_nop 0
    buffer_load_dwordx4 v10, s[16:19], s55 offen offset:0 lds
    v_mfma_f32_16x16x32_bf16 v[188:191], v[28:31], v[56:59], v[188:191]
    v_mfma_f32_16x16x32_bf16 v[224:227], v[32:35], v[56:59], v[224:227]
    ds_read_b128 v[56:59], v6 offset:10240
    s_waitcnt lgkmcnt(12)
    v_mfma_f32_16x16x32_bf16 v[120:123], v[20:23], v[60:63], v[120:123]
    v_mfma_f32_16x16x32_bf16 v[156:159], v[24:27], v[60:63], v[156:159]
    v_mfma_f32_16x16x32_bf16 v[192:195], v[28:31], v[60:63], v[192:195]
    v_mfma_f32_16x16x32_bf16 v[228:231], v[32:35], v[60:63], v[228:231]
    ds_read_b128 v[60:63], v6 offset:11264
    s_waitcnt lgkmcnt(12)
    v_mfma_f32_16x16x32_bf16 v[124:127], v[20:23], v[64:67], v[124:127]
    v_mfma_f32_16x16x32_bf16 v[160:163], v[24:27], v[64:67], v[160:163]
    buffer_load_dwordx4 v11, s[16:19], s55 offen offset:1024 lds
    v_mfma_f32_16x16x32_bf16 v[196:199], v[28:31], v[64:67], v[196:199]
    v_mfma_f32_16x16x32_bf16 v[232:235], v[32:35], v[64:67], v[232:235]
    ds_read_b128 v[64:67], v6 offset:12288
    s_waitcnt lgkmcnt(12)
    v_mfma_f32_16x16x32_bf16 v[128:131], v[20:23], v[68:71], v[128:131]
    v_mfma_f32_16x16x32_bf16 v[164:167], v[24:27], v[68:71], v[164:167]
    v_mfma_f32_16x16x32_bf16 v[200:203], v[28:31], v[68:71], v[200:203]
    v_mfma_f32_16x16x32_bf16 v[236:239], v[32:35], v[68:71], v[236:239]
    ds_read_b128 v[68:71], v6 offset:13312
    s_waitcnt lgkmcnt(12)
    v_mfma_f32_16x16x32_bf16 v[132:135], v[20:23], v[72:75], v[132:135]
    v_mfma_f32_16x16x32_bf16 v[168:171], v[24:27], v[72:75], v[168:171]
    buffer_load_dwordx4 v12, s[16:19], s55 offen offset:2048 lds
    v_mfma_f32_16x16x32_bf16 v[204:207], v[28:31], v[72:75], v[204:207]
    v_mfma_f32_16x16x32_bf16 v[240:243], v[32:35], v[72:75], v[240:243]
    ds_read_b128 v[72:75], v6 offset:14336
    s_waitcnt lgkmcnt(12)
    v_mfma_f32_16x16x32_bf16 v[136:139], v[20:23], v[76:79], v[136:139]
    v_mfma_f32_16x16x32_bf16 v[172:175], v[24:27], v[76:79], v[172:175]
    v_mfma_f32_16x16x32_bf16 v[208:211], v[28:31], v[76:79], v[208:211]
    v_mfma_f32_16x16x32_bf16 v[244:247], v[32:35], v[76:79], v[244:247]
    ds_read_b128 v[76:79], v6 offset:15360
    s_waitcnt lgkmcnt(12)
    v_mfma_f32_16x16x32_bf16 v[140:143], v[20:23], v[80:83], v[140:143]
    v_mfma_f32_16x16x32_bf16 v[176:179], v[24:27], v[80:83], v[176:179]
    buffer_load_dwordx4 v13, s[16:19], s55 offen offset:3072 lds
    v_mfma_f32_16x16x32_bf16 v[212:215], v[28:31], v[80:83], v[212:215]
    v_mfma_f32_16x16x32_bf16 v[248:251], v[32:35], v[80:83], v[248:251]
    ds_read_b128 v[80:83], v6 offset:16384
    s_waitcnt lgkmcnt(12)
    v_mfma_f32_16x16x32_bf16 v[144:147], v[84:87], v[20:23], v[144:147]
    v_mfma_f32_16x16x32_bf16 v[180:183], v[84:87], v[24:27], v[180:183]
    v_mfma_f32_16x16x32_bf16 v[216:219], v[84:87], v[28:31], v[216:219]
    v_mfma_f32_16x16x32_bf16 v[252:255], v[84:87], v[32:35], v[252:255]
    ds_read_b128 v[84:87], v6 offset:17408
    s_waitcnt lgkmcnt(8)
    v_mfma_f32_16x16x32_bf16 v[112:115], v[36:39], v[52:55], v[112:115]
    v_mfma_f32_16x16x32_bf16 v[148:151], v[40:43], v[52:55], v[148:151]
    s_add_u32 m0, s58, 36864
    s_nop 0
    buffer_load_dwordx4 v14, s[16:19], s55 offen offset:0 lds
    v_mfma_f32_16x16x32_bf16 v[184:187], v[44:47], v[52:55], v[184:187]
    v_mfma_f32_16x16x32_bf16 v[220:223], v[48:51], v[52:55], v[220:223]
    s_waitcnt lgkmcnt(7)
    v_mfma_f32_16x16x32_bf16 v[116:119], v[36:39], v[56:59], v[116:119]
    v_mfma_f32_16x16x32_bf16 v[152:155], v[40:43], v[56:59], v[152:155]
    v_mfma_f32_16x16x32_bf16 v[188:191], v[44:47], v[56:59], v[188:191]
    v_mfma_f32_16x16x32_bf16 v[224:227], v[48:51], v[56:59], v[224:227]
    s_waitcnt vmcnt(5)
    s_waitcnt lgkmcnt(0)
    s_barrier
    v_mfma_f32_16x16x32_bf16 v[120:123], v[36:39], v[60:63], v[120:123]
    ds_read_b128 v[20:23], v2 offset:0
    v_mfma_f32_16x16x32_bf16 v[156:159], v[40:43], v[60:63], v[156:159]
    ds_read_b128 v[24:27], v2 offset:2048
    v_mfma_f32_16x16x32_bf16 v[192:195], v[44:47], v[60:63], v[192:195]
    ds_read_b128 v[28:31], v2 offset:4096
    v_mfma_f32_16x16x32_bf16 v[228:231], v[48:51], v[60:63], v[228:231]
    ds_read_b128 v[32:35], v2 offset:6144
    v_mfma_f32_16x16x32_bf16 v[124:127], v[36:39], v[64:67], v[124:127]
    ds_read_b128 v[52:55], v6 offset:18432
    v_mfma_f32_16x16x32_bf16 v[160:163], v[40:43], v[64:67], v[160:163]
    ds_read_b128 v[56:59], v6 offset:19456
    v_mfma_f32_16x16x32_bf16 v[196:199], v[44:47], v[64:67], v[196:199]
    ds_read_b128 v[60:63], v6 offset:20480
    v_mfma_f32_16x16x32_bf16 v[232:235], v[48:51], v[64:67], v[232:235]
    ds_read_b128 v[64:67], v6 offset:21504
    v_mfma_f32_16x16x32_bf16 v[128:131], v[36:39], v[68:71], v[128:131]
    buffer_load_dwordx4 v15, s[16:19], s55 offen offset:1024 lds
    v_mfma_f32_16x16x32_bf16 v[164:167], v[40:43], v[68:71], v[164:167]
    v_mfma_f32_16x16x32_bf16 v[200:203], v[44:47], v[68:71], v[200:203]
    v_mfma_f32_16x16x32_bf16 v[236:239], v[48:51], v[68:71], v[236:239]
    ds_read_b128 v[68:71], v6 offset:22528
    v_mfma_f32_16x16x32_bf16 v[132:135], v[36:39], v[72:75], v[132:135]
    v_mfma_f32_16x16x32_bf16 v[168:171], v[40:43], v[72:75], v[168:171]
    v_mfma_f32_16x16x32_bf16 v[204:207], v[44:47], v[72:75], v[204:207]
    v_mfma_f32_16x16x32_bf16 v[240:243], v[48:51], v[72:75], v[240:243]
    ds_read_b128 v[72:75], v6 offset:23552
    v_mfma_f32_16x16x32_bf16 v[136:139], v[36:39], v[76:79], v[136:139]
    buffer_load_dwordx4 v16, s[16:19], s55 offen offset:2048 lds
    v_mfma_f32_16x16x32_bf16 v[172:175], v[40:43], v[76:79], v[172:175]
    v_mfma_f32_16x16x32_bf16 v[208:211], v[44:47], v[76:79], v[208:211]
    v_mfma_f32_16x16x32_bf16 v[244:247], v[48:51], v[76:79], v[244:247]
    ds_read_b128 v[76:79], v6 offset:24576
    v_mfma_f32_16x16x32_bf16 v[140:143], v[36:39], v[80:83], v[140:143]
    v_mfma_f32_16x16x32_bf16 v[176:179], v[40:43], v[80:83], v[176:179]
    v_mfma_f32_16x16x32_bf16 v[212:215], v[44:47], v[80:83], v[212:215]
    v_mfma_f32_16x16x32_bf16 v[248:251], v[48:51], v[80:83], v[248:251]
    ds_read_b128 v[80:83], v6 offset:25600
    v_mfma_f32_16x16x32_bf16 v[144:147], v[84:87], v[36:39], v[144:147]
    buffer_load_dwordx4 v17, s[16:19], s55 offen offset:3072 lds
    s_add_u32 s55, s55, 128
    s_cmp_ge_u32 s55, 1152
    s_cselect_b32 s55, 0, s55
    v_mfma_f32_16x16x32_bf16 v[180:183], v[84:87], v[40:43], v[180:183]
    v_mfma_f32_16x16x32_bf16 v[216:219], v[84:87], v[44:47], v[216:219]
    v_mfma_f32_16x16x32_bf16 v[252:255], v[84:87], v[48:51], v[252:255]
    ds_read_b128 v[84:87], v6 offset:26624
    s_waitcnt lgkmcnt(8)
    v_mfma_f32_16x16x32_bf16 v[112:115], v[20:23], v[52:55], v[112:115]
    ds_read_b128 v[36:39], v3 offset:0
    v_mfma_f32_16x16x32_bf16 v[148:151], v[24:27], v[52:55], v[148:151]
    ds_read_b128 v[40:43], v3 offset:2048
    v_mfma_f32_16x16x32_bf16 v[184:187], v[28:31], v[52:55], v[184:187]
    ds_read_b128 v[44:47], v3 offset:4096
    v_mfma_f32_16x16x32_bf16 v[220:223], v[32:35], v[52:55], v[220:223]
    ds_read_b128 v[48:51], v3 offset:6144
    s_waitcnt lgkmcnt(11)
    v_mfma_f32_16x16x32_bf16 v[116:119], v[20:23], v[56:59], v[116:119]
    ds_read_b128 v[52:55], v6 offset:27648
    v_mfma_f32_16x16x32_bf16 v[152:155], v[24:27], v[56:59], v[152:155]
    s_add_u32 m0, s58, 65536
    s_nop 0
    buffer_load_dwordx4 v10, s[16:19], s55 offen offset:0 lds
    v_mfma_f32_16x16x32_bf16 v[188:191], v[28:31], v[56:59], v[188:191]
    v_mfma_f32_16x16x32_bf16 v[224:227], v[32:35], v[56:59], v[224:227]
    ds_read_b128 v[56:59], v6 offset:28672
    s_waitcnt lgkmcnt(12)
    v_mfma_f32_16x16x32_bf16 v[120:123], v[20:23], v[60:63], v[120:123]
    v_mfma_f32_16x16x32_bf16 v[156:159], v[24:27], v[60:63], v[156:159]
    v_mfma_f32_16x16x32_bf16 v[192:195], v[28:31], v[60:63], v[192:195]
    v_mfma_f32_16x16x32_bf16 v[228:231], v[32:35], v[60:63], v[228:231]
    ds_read_b128 v[60:63], v6 offset:29696
    s_waitcnt lgkmcnt(12)
    v_mfma_f32_16x16x32_bf16 v[124:127], v[20:23], v[64:67], v[124:127]
    v_mfma_f32_16x16x32_bf16 v[160:163], v[24:27], v[64:67], v[160:163]
    buffer_load_dwordx4 v11, s[16:19], s55 offen offset:1024 lds
    v_mfma_f32_16x16x32_bf16 v[196:199], v[28:31], v[64:67], v[196:199]
    v_mfma_f32_16x16x32_bf16 v[232:235], v[32:35], v[64:67], v[232:235]
    ds_read_b128 v[64:67], v6 offset:30720
    s_waitcnt lgkmcnt(12)
    v_mfma_f32_16x16x32_bf16 v[128:131], v[20:23], v[68:71], v[128:131]
    v_mfma_f32_16x16x32_bf16 v[164:167], v[24:27], v[68:71], v[164:167]
    v_mfma_f32_16x16x32_bf16 v[200:203], v[28:31], v[68:71], v[200:203]
    v_mfma_f32_16x16x32_bf16 v[236:239], v[32:35], v[68:71], v[236:239]
    ds_read_b128 v[68:71], v6 offset:31744
    s_waitcnt lgkmcnt(12)
    v_mfma_f32_16x16x32_bf16 v[132:135], v[20:23], v[72:75], v[132:135]
    v_mfma_f32_16x16x32_bf16 v[168:171], v[24:27], v[72:75], v[168:171]
    buffer_load_dwordx4 v12, s[16:19], s55 offen offset:2048 lds
    v_mfma_f32_16x16x32_bf16 v[204:207], v[28:31], v[72:75], v[204:207]
    v_mfma_f32_16x16x32_bf16 v[240:243], v[32:35], v[72:75], v[240:243]
    ds_read_b128 v[72:75], v6 offset:32768
    s_waitcnt lgkmcnt(12)
    v_mfma_f32_16x16x32_bf16 v[136:139], v[20:23], v[76:79], v[136:139]
    v_mfma_f32_16x16x32_bf16 v[172:175], v[24:27], v[76:79], v[172:175]
    v_mfma_f32_16x16x32_bf16 v[208:211], v[28:31], v[76:79], v[208:211]
    v_mfma_f32_16x16x32_bf16 v[244:247], v[32:35], v[76:79], v[244:247]
    ds_read_b128 v[76:79], v6 offset:33792
    s_waitcnt lgkmcnt(12)
    v_mfma_f32_16x16x32_bf16 v[140:143], v[20:23], v[80:83], v[140:143]
    v_mfma_f32_16x16x32_bf16 v[176:179], v[24:27], v[80:83], v[176:179]
    buffer_load_dwordx4 v13, s[16:19], s55 offen offset:3072 lds
    v_mfma_f32_16x16x32_bf16 v[212:215], v[28:31], v[80:83], v[212:215]
    v_mfma_f32_16x16x32_bf16 v[248:251], v[32:35], v[80:83], v[248:251]
    ds_read_b128 v[80:83], v6 offset:34816
    s_waitcnt lgkmcnt(12)
    v_mfma_f32_16x16x32_bf16 v[144:147], v[84:87], v[20:23], v[144:147]
    v_mfma_f32_16x16x32_bf16 v[180:183], v[84:87], v[24:27], v[180:183]
    v_mfma_f32_16x16x32_bf16 v[216:219], v[84:87], v[28:31], v[216:219]
    v_mfma_f32_16x16x32_bf16 v[252:255], v[84:87], v[32:35], v[252:255]
    ds_read_b128 v[84:87], v6 offset:35840
    s_waitcnt lgkmcnt(8)
    v_mfma_f32_16x16x32_bf16 v[112:115], v[36:39], v[52:55], v[112:115]
    v_mfma_f32_16x16x32_bf16 v[148:151], v[40:43], v[52:55], v[148:151]
    s_add_u32 m0, s58, 69632
    s_nop 0
    buffer_load_dwordx4 v14, s[16:19], s55 offen offset:0 lds
    v_mfma_f32_16x16x32_bf16 v[184:187], v[44:47], v[52:55], v[184:187]
    v_mfma_f32_16x16x32_bf16 v[220:223], v[48:51], v[52:55], v[220:223]
    s_waitcnt lgkmcnt(7)
    v_mfma_f32_16x16x32_bf16 v[116:119], v[36:39], v[56:59], v[116:119]
    v_mfma_f32_16x16x32_bf16 v[152:155], v[40:43], v[56:59], v[152:155]
    v_mfma_f32_16x16x32_bf16 v[188:191], v[44:47], v[56:59], v[188:191]
    v_mfma_f32_16x16x32_bf16 v[224:227], v[48:51], v[56:59], v[224:227]
    s_waitcnt vmcnt(5)
    s_waitcnt lgkmcnt(0)
    s_barrier
    v_mfma_f32_16x16x32_bf16 v[120:123], v[36:39], v[60:63], v[120:123]
    ds_read_b128 v[20:23], v2 offset:32768
    v_mfma_f32_16x16x32_bf16 v[156:159], v[40:43], v[60:63], v[156:159]
    ds_read_b128 v[24:27], v2 offset:34816
    v_mfma_f32_16x16x32_bf16 v[192:195], v[44:47], v[60:63], v[192:195]
    ds_read_b128 v[28:31], v2 offset:36864
    v_mfma_f32_16x16x32_bf16 v[228:231], v[48:51], v[60:63], v[228:231]
    ds_read_b128 v[32:35], v2 offset:38912
    v_mfma_f32_16x16x32_bf16 v[124:127], v[36:39], v[64:67], v[124:127]
    ds_read_b128 v[52:55], v6 offset:0
    v_mfma_f32_16x16x32_bf16 v[160:163], v[40:43], v[64:67], v[160:163]
    ds_read_b128 v[56:59], v6 offset:1024
    v_mfma_f32_16x16x32_bf16 v[196:199], v[44:47], v[64:67], v[196:199]
    ds_read_b128 v[60:63], v6 offset:2048
    v_mfma_f32_16x16x32_bf16 v[232:235], v[48:51], v[64:67], v[232:235]
    ds_read_b128 v[64:67], v6 offset:3072
    v_mfma_f32_16x16x32_bf16 v[128:131], v[36:39], v[68:71], v[128:131]
    buffer_load_dwordx4 v15, s[16:19], s55 offen offset:1024 lds
    v_mfma_f32_16x16x32_bf16 v[164:167], v[40:43], v[68:71], v[164:167]
    v_mfma_f32_16x16x32_bf16 v[200:203], v[44:47], v[68:71], v[200:203]
    v_mfma_f32_16x16x32_bf16 v[236:239], v[48:51], v[68:71], v[236:239]
    ds_read_b128 v[68:71], v6 offset:4096
    v_mfma_f32_16x16x32_bf16 v[132:135], v[36:39], v[72:75], v[132:135]
    v_mfma_f32_16x16x32_bf16 v[168:171], v[40:43], v[72:75], v[168:171]
    v_mfma_f32_16x16x32_bf16 v[204:207], v[44:47], v[72:75], v[204:207]
    v_mfma_f32_16x16x32_bf16 v[240:243], v[48:51], v[72:75], v[240:243]
    ds_read_b128 v[72:75], v6 offset:5120
    v_mfma_f32_16x16x32_bf16 v[136:139], v[36:39], v[76:79], v[136:139]
    buffer_load_dwordx4 v16, s[16:19], s55 offen offset:2048 lds
    v_mfma_f32_16x16x32_bf16 v[172:175], v[40:43], v[76:79], v[172:175]
    v_mfma_f32_16x16x32_bf16 v[208:211], v[44:47], v[76:79], v[208:211]
    v_mfma_f32_16x16x32_bf16 v[244:247], v[48:51], v[76:79], v[244:247]
    ds_read_b128 v[76:79], v6 offset:6144
    v_mfma_f32_16x16x32_bf16 v[140:143], v[36:39], v[80:83], v[140:143]
    v_mfma_f32_16x16x32_bf16 v[176:179], v[40:43], v[80:83], v[176:179]
    v_mfma_f32_16x16x32_bf16 v[212:215], v[44:47], v[80:83], v[212:215]
    v_mfma_f32_16x16x32_bf16 v[248:251], v[48:51], v[80:83], v[248:251]
    ds_read_b128 v[80:83], v6 offset:7168
    v_mfma_f32_16x16x32_bf16 v[144:147], v[84:87], v[36:39], v[144:147]
    buffer_load_dwordx4 v17, s[16:19], s55 offen offset:3072 lds
    s_add_u32 s55, s55, 128
    s_cmp_ge_u32 s55, 1152
    s_cselect_b32 s55, 0, s55
    v_mfma_f32_16x16x32_bf16 v[180:183], v[84:87], v[40:43], v[180:183]
    v_mfma_f32_16x16x32_bf16 v[216:219], v[84:87], v[44:47], v[216:219]
    v_mfma_f32_16x16x32_bf16 v[252:255], v[84:87], v[48:51], v[252:255]
    ds_read_b128 v[84:87], v6 offset:8192
    s_waitcnt lgkmcnt(8)
    v_mfma_f32_16x16x32_bf16 v[112:115], v[20:23], v[52:55], v[112:115]
    ds_read_b128 v[36:39], v3 offset:32768
    v_mfma_f32_16x16x32_bf16 v[148:151], v[24:27], v[52:55], v[148:151]
    ds_read_b128 v[40:43], v3 offset:34816
    v_mfma_f32_16x16x32_bf16 v[184:187], v[28:31], v[52:55], v[184:187]
    ds_read_b128 v[44:47], v3 offset:36864
    v_mfma_f32_16x16x32_bf16 v[220:223], v[32:35], v[52:55], v[220:223]
    ds_read_b128 v[48:51], v3 offset:38912
    s_waitcnt lgkmcnt(11)
    v_mfma_f32_16x16x32_bf16 v[116:119], v[20:23], v[56:59], v[116:119]
    ds_read_b128 v[52:55], v6 offset:9216
    v_mfma_f32_16x16x32_bf16 v[152:155], v[24:27], v[56:59], v[152:155]
    s_add_u32 m0, s58, 0
    s_nop 0
    buffer_load_dwordx4 v10, s[16:19], s55 offen offset:0 lds
    v_mfma_f32_16x16x32_bf16 v[188:191], v[28:31], v[56:59], v[188:191]
    v_mfma_f32_16x16x32_bf16 v[224:227], v[32:35], v[56:59], v[224:227]
    ds_read_b128 v[56:59], v6 offset:10240
    s_waitcnt lgkmcnt(12)
    v_mfma_f32_16x16x32_bf16 v[120:123], v[20:23], v[60:63], v[120:123]
    v_mfma_f32_16x16x32_bf16 v[156:159], v[24:27], v[60:63], v[156:159]
    v_mfma_f32_16x16x32_bf16 v[192:195], v[28:31], v[60:63], v[192:195]
    v_mfma_f32_16x16x32_bf16 v[228:231], v[32:35], v[60:63], v[228:231]
    ds_read_b128 v[60:63], v6 offset:11264
    s_waitcnt lgkmcnt(12)
    v_mfma_f32_16x16x32_bf16 v[124:127], v[20:23], v[64:67], v[124:127]
    v_mfma_f32_16x16x32_bf16 v[160:163], v[24:27], v[64:67], v[160:163]
    buffer_load_dwordx4 v11, s[16:19], s55 offen offset:1024 lds
    v_mfma_f32_16x16x32_bf16 v[196:199], v[28:31], v[64:67], v[196:199]
    v_mfma_f32_16x16x32_bf16 v[232:235], v[32:35], v[64:67], v[232:235]
    ds_read_b128 v[64:67], v6 offset:12288
    s_waitcnt lgkmcnt(12)
    v_mfma_f32_16x16x32_bf16 v[128:131], v[20:23], v[68:71], v[128:131]
    v_mfma_f32_16x16x32_bf16 v[164:167], v[24:27], v[68:71], v[164:167]
    v_mfma_f32_16x16x32_bf16 v[200:203], v[28:31], v[68:71], v[200:203]
    v_mfma_f32_16x16x32_bf16 v[236:239], v[32:35], v[68:71], v[236:239]
    ds_read_b128 v[68:71], v6 offset:13312
    s_waitcnt lgkmcnt(12)
    v_mfma_f32_16x16x32_bf16 v[132:135], v[20:23], v[72:75], v[132:135]
    v_mfma_f32_16x16x32_bf16 v[168:171], v[24:27], v[72:75], v[168:171]
    buffer_load_dwordx4 v12, s[16:19], s55 offen offset:2048 lds
    v_mfma_f32_16x16x32_bf16 v[204:207], v[28:31], v[72:75], v[204:207]
    v_mfma_f32_16x16x32_bf16 v[240:243], v[32:35], v[72:75], v[240:243]
    ds_read_b128 v[72:75], v6 offset:14336
    s_waitcnt lgkmcnt(12)
    v_mfma_f32_16x16x32_bf16 v[136:139], v[20:23], v[76:79], v[136:139]
    v_mfma_f32_16x16x32_bf16 v[172:175], v[24:27], v[76:79], v[172:175]
    v_mfma_f32_16x16x32_bf16 v[208:211], v[28:31], v[76:79], v[208:211]
    v_mfma_f32_16x16x32_bf16 v[244:247], v[32:35], v[76:79], v[244:247]
    ds_read_b128 v[76:79], v6 offset:15360
    s_waitcnt lgkmcnt(12)
    v_mfma_f32_16x16x32_bf16 v[140:143], v[20:23], v[80:83], v[140:143]
    v_mfma_f32_16x16x32_bf16 v[176:179], v[24:27], v[80:83], v[176:179]
    buffer_load_dwordx4 v13, s[16:19], s55 offen offset:3072 lds
    v_mfma_f32_16x16x32_bf16 v[212:215], v[28:31], v[80:83], v[212:215]
    v_mfma_f32_16x16x32_bf16 v[248:251], v[32:35], v[80:83], v[248:251]
    ds_read_b128 v[80:83], v6 offset:16384
    s_waitcnt lgkmcnt(12)
    v_mfma_f32_16x16x32_bf16 v[144:147], v[84:87], v[20:23], v[144:147]
    v_mfma_f32_16x16x32_bf16 v[180:183], v[84:87], v[24:27], v[180:183]
    v_mfma_f32_16x16x32_bf16 v[216:219], v[84:87], v[28:31], v[216:219]
    v_mfma_f32_16x16x32_bf16 v[252:255], v[84:87], v[32:35], v[252:255]
    ds_read_b128 v[84:87], v6 offset:17408
    s_waitcnt lgkmcnt(8)
    v_mfma_f32_16x16x32_bf16 v[112:115], v[36:39], v[52:55], v[112:115]
    v_mfma_f32_16x16x32_bf16 v[148:151], v[40:43], v[52:55], v[148:151]
    s_add_u32 m0, s58, 4096
    s_nop 0
    buffer_load_dwordx4 v14, s[16:19], s55 offen offset:0 lds
    v_mfma_f32_16x16x32_bf16 v[184:187], v[44:47], v[52:55], v[184:187]
    v_mfma_f32_16x16x32_bf16 v[220:223], v[48:51], v[52:55], v[220:223]
    s_waitcnt lgkmcnt(7)
    v_mfma_f32_16x16x32_bf16 v[116:119], v[36:39], v[56:59], v[116:119]
    v_mfma_f32_16x16x32_bf16 v[152:155], v[40:43], v[56:59], v[152:155]
    v_mfma_f32_16x16x32_bf16 v[188:191], v[44:47], v[56:59], v[188:191]
    v_mfma_f32_16x16x32_bf16 v[224:227], v[48:51], v[56:59], v[224:227]
    s_waitcnt vmcnt(5)
    s_waitcnt lgkmcnt(0)
    s_barrier
    v_mfma_f32_16x16x32_bf16 v[120:123], v[36:39], v[60:63], v[120:123]
    ds_read_b128 v[20:23], v4 offset:0
    v_mfma_f32_16x16x32_bf16 v[156:159], v[40:43], v[60:63], v[156:159]
    ds_read_b128 v[24:27], v4 offset:2048
    v_mfma_f32_16x16x32_bf16 v[192:195], v[44:47], v[60:63], v[192:195]
    ds_read_b128 v[28:31], v4 offset:4096
    v_mfma_f32_16x16x32_bf16 v[228:231], v[48:51], v[60:63], v[228:231]
    ds_read_b128 v[32:35], v4 offset:6144
    v_mfma_f32_16x16x32_bf16 v[124:127], v[36:39], v[64:67], v[124:127]
    ds_read_b128 v[52:55], v6 offset:18432
    v_mfma_f32_16x16x32_bf16 v[160:163], v[40:43], v[64:67], v[160:163]
    ds_read_b128 v[56:59], v6 offset:19456
    v_mfma_f32_16x16x32_bf16 v[196:199], v[44:47], v[64:67], v[196:199]
    ds_read_b128 v[60:63], v6 offset:20480
    v_mfma_f32_16x16x32_bf16 v[232:235], v[48:51], v[64:67], v[232:235]
    ds_read_b128 v[64:67], v6 offset:21504
    v_mfma_f32_16x16x32_bf16 v[128:131], v[36:39], v[68:71], v[128:131]
    buffer_load_dwordx4 v15, s[16:19], s55 offen offset:1024 lds
    v_mfma_f32_16x16x32_bf16 v[164:167], v[40:43], v[68:71], v[164:167]
    v_mfma_f32_16x16x32_bf16 v[200:203], v[44:47], v[68:71], v[200:203]
    v_mfma_f32_16x16x32_bf16 v[236:239], v[48:51], v[68:71], v[236:239]
    ds_read_b128 v[68:71], v6 offset:22528
    v_mfma_f32_16x16x32_bf16 v[132:135], v[36:39], v[72:75], v[132:135]
    v_mfma_f32_16x16x32_bf16 v[168:171], v[40:43], v[72:75], v[168:171]
    v_mfma_f32_16x16x32_bf16 v[204:207], v[44:47], v[72:75], v[204:207]
    v_mfma_f32_16x16x32_bf16 v[240:243], v[48:51], v[72:75], v[240:243]
    ds_read_b128 v[72:75], v6 offset:23552
    v_mfma_f32_16x16x32_bf16 v[136:139], v[36:39], v[76:79], v[136:139]
    buffer_load_dwordx4 v16, s[16:19], s55 offen offset:2048 lds
    v_mfma_f32_16x16x32_bf16 v[172:175], v[40:43], v[76:79], v[172:175]
    v_mfma_f32_16x16x32_bf16 v[208:211], v[44:47], v[76:79], v[208:211]
    v_mfma_f32_16x16x32_bf16 v[244:247], v[48:51], v[76:79], v[244:247]
    ds_read_b128 v[76:79], v6 offset:24576
    v_mfma_f32_16x16x32_bf16 v[140:143], v[36:39], v[80:83], v[140:143]
    v_mfma_f32_16x16x32_bf16 v[176:179], v[40:43], v[80:83], v[176:179]
    v_mfma_f32_16x16x32_bf16 v[212:215], v[44:47], v[80:83], v[212:215]
    v_mfma_f32_16x16x32_bf16 v[248:251], v[48:51], v[80:83], v[248:251]
    ds_read_b128 v[80:83], v6 offset:25600
    v_mfma_f32_16x16x32_bf16 v[144:147], v[84:87], v[36:39], v[144:147]
    buffer_load_dwordx4 v17, s[16:19], s55 offen offset:3072 lds
    s_add_u32 s55, s55, 128
    s_cmp_ge_u32 s55, 1152
    s_cselect_b32 s55, 0, s55
    v_mfma_f32_16x16x32_bf16 v[180:183], v[84:87], v[40:43], v[180:183]
    v_mfma_f32_16x16x32_bf16 v[216:219], v[84:87], v[44:47], v[216:219]
    v_mfma_f32_16x16x32_bf16 v[252:255], v[84:87], v[48:51], v[252:255]
    ds_read_b128 v[84:87], v6 offset:26624
    s_waitcnt lgkmcnt(8)
    v_mfma_f32_16x16x32_bf16 v[112:115], v[20:23], v[52:55], v[112:115]
    ds_read_b128 v[36:39], v5 offset:0
    v_mfma_f32_16x16x32_bf16 v[148:151], v[24:27], v[52:55], v[148:151]
    ds_read_b128 v[40:43], v5 offset:2048
    v_mfma_f32_16x16x32_bf16 v[184:187], v[28:31], v[52:55], v[184:187]
    ds_read_b128 v[44:47], v5 offset:4096
    v_mfma_f32_16x16x32_bf16 v[220:223], v[32:35], v[52:55], v[220:223]
    ds_read_b128 v[48:51], v5 offset:6144
    s_waitcnt lgkmcnt(11)
    v_mfma_f32_16x16x32_bf16 v[116:119], v[20:23], v[56:59], v[116:119]
    ds_read_b128 v[52:55], v6 offset:27648
    v_mfma_f32_16x16x32_bf16 v[152:155], v[24:27], v[56:59], v[152:155]
    s_add_u32 m0, s58, 32768
    s_nop 0
    buffer_load_dwordx4 v10, s[16:19], s55 offen offset:0 lds
    v_mfma_f32_16x16x32_bf16 v[188:191], v[28:31], v[56:59], v[188:191]
    v_mfma_f32_16x16x32_bf16 v[224:227], v[32:35], v[56:59], v[224:227]
    ds_read_b128 v[56:59], v6 offset:28672
    s_waitcnt lgkmcnt(12)
    v_mfma_f32_16x16x32_bf16 v[120:123], v[20:23], v[60:63], v[120:123]
    v_mfma_f32_16x16x32_bf16 v[156:159], v[24:27], v[60:63], v[156:159]
    v_mfma_f32_16x16x32_bf16 v[192:195], v[28:31], v[60:63], v[192:195]
    v_mfma_f32_16x16x32_bf16 v[228:231], v[32:35], v[60:63], v[228:231]
    ds_read_b128 v[60:63], v6 offset:29696
    s_waitcnt lgkmcnt(12)
    v_mfma_f32_16x16x32_bf16 v[124:127], v[20:23], v[64:67], v[124:127]
    v_mfma_f32_16x16x32_bf16 v[160:163], v[24:27], v[64:67], v[160:163]
    buffer_load_dwordx4 v11, s[16:19], s55 offen offset:1024 lds
    v_mfma_f32_16x16x32_bf16 v[196:199], v[28:31], v[64:67], v[196:199]
    v_mfma_f32_16x16x32_bf16 v[232:235], v[32:35], v[64:67], v[232:235]
    ds_read_b128 v[64:67], v6 offset:30720
    s_waitcnt lgkmcnt(12)
    v_mfma_f32_16x16x32_bf16 v[128:131], v[20:23], v[68:71], v[128:131]
    v_mfma_f32_16x16x32_bf16 v[164:167], v[24:27], v[68:71], v[164:167]
    v_mfma_f32_16x16x32_bf16 v[200:203], v[28:31], v[68:71], v[200:203]
    v_mfma_f32_16x16x32_bf16 v[236:239], v[32:35], v[68:71], v[236:239]
    ds_read_b128 v[68:71], v6 offset:31744
    s_waitcnt lgkmcnt(12)
    v_mfma_f32_16x16x32_bf16 v[132:135], v[20:23], v[72:75], v[132:135]
    v_mfma_f32_16x16x32_bf16 v[168:171], v[24:27], v[72:75], v[168:171]
    buffer_load_dwordx4 v12, s[16:19], s55 offen offset:2048 lds
    v_mfma_f32_16x16x32_bf16 v[204:207], v[28:31], v[72:75], v[204:207]
    v_mfma_f32_16x16x32_bf16 v[240:243], v[32:35], v[72:75], v[240:243]
    ds_read_b128 v[72:75], v6 offset:32768
    s_waitcnt lgkmcnt(12)
    v_mfma_f32_16x16x32_bf16 v[136:139], v[20:23], v[76:79], v[136:139]
    v_mfma_f32_16x16x32_bf16 v[172:175], v[24:27], v[76:79], v[172:175]
    v_mfma_f32_16x16x32_bf16 v[208:211], v[28:31], v[76:79], v[208:211]
    v_mfma_f32_16x16x32_bf16 v[244:247], v[32:35], v[76:79], v[244:247]
    ds_read_b128 v[76:79], v6 offset:33792
    s_waitcnt lgkmcnt(12)
    v_mfma_f32_16x16x32_bf16 v[140:143], v[20:23], v[80:83], v[140:143]
    v_mfma_f32_16x16x32_bf16 v[176:179], v[24:27], v[80:83], v[176:179]
    buffer_load_dwordx4 v13, s[16:19], s55 offen offset:3072 lds
    v_mfma_f32_16x16x32_bf16 v[212:215], v[28:31], v[80:83], v[212:215]
    v_mfma_f32_16x16x32_bf16 v[248:251], v[32:35], v[80:83], v[248:251]
    ds_read_b128 v[80:83], v6 offset:34816
    s_waitcnt lgkmcnt(12)
    v_mfma_f32_16x16x32_bf16 v[144:147], v[84:87], v[20:23], v[144:147]
    v_mfma_f32_16x16x32_bf16 v[180:183], v[84:87], v[24:27], v[180:183]
    v_mfma_f32_16x16x32_bf16 v[216:219], v[84:87], v[28:31], v[216:219]
    v_mfma_f32_16x16x32_bf16 v[252:255], v[84:87], v[32:35], v[252:255]
    ds_read_b128 v[84:87], v6 offset:35840
    s_waitcnt lgkmcnt(8)
    v_mfma_f32_16x16x32_bf16 v[112:115], v[36:39], v[52:55], v[112:115]
    v_mfma_f32_16x16x32_bf16 v[148:151], v[40:43], v[52:55], v[148:151]
    s_add_u32 m0, s58, 36864
    s_nop 0
    buffer_load_dwordx4 v14, s[16:19], s55 offen offset:0 lds
    v_mfma_f32_16x16x32_bf16 v[184:187], v[44:47], v[52:55], v[184:187]
    v_mfma_f32_16x16x32_bf16 v[220:223], v[48:51], v[52:55], v[220:223]
    s_waitcnt lgkmcnt(7)
    v_mfma_f32_16x16x32_bf16 v[116:119], v[36:39], v[56:59], v[116:119]
    v_mfma_f32_16x16x32_bf16 v[152:155], v[40:43], v[56:59], v[152:155]
    v_mfma_f32_16x16x32_bf16 v[188:191], v[44:47], v[56:59], v[188:191]
    v_mfma_f32_16x16x32_bf16 v[224:227], v[48:51], v[56:59], v[224:227]
    s_waitcnt vmcnt(5)
    s_waitcnt lgkmcnt(0)
    s_barrier
    v_mfma_f32_16x16x32_bf16 v[120:123], v[36:39], v[60:63], v[120:123]
    ds_read_b128 v[20:23], v2 offset:0
    v_mfma_f32_16x16x32_bf16 v[156:159], v[40:43], v[60:63], v[156:159]
    ds_read_b128 v[24:27], v2 offset:2048
    v_mfma_f32_16x16x32_bf16 v[192:195], v[44:47], v[60:63], v[192:195]
    ds_read_b128 v[28:31], v2 offset:4096
    v_mfma_f32_16x16x32_bf16 v[228:231], v[48:51], v[60:63], v[228:231]
    ds_read_b128 v[32:35], v2 offset:6144
    v_mfma_f32_16x16x32_bf16 v[124:127], v[36:39], v[64:67], v[124:127]
    ds_read_b128 v[52:55], v6 offset:0
    v_mfma_f32_16x16x32_bf16 v[160:163], v[40:43], v[64:67], v[160:163]
    ds_read_b128 v[56:59], v6 offset:1024
    v_mfma_f32_16x16x32_bf16 v[196:199], v[44:47], v[64:67], v[196:199]
    ds_read_b128 v[60:63], v6 offset:2048
    v_mfma_f32_16x16x32_bf16 v[232:235], v[48:51], v[64:67], v[232:235]
    ds_read_b128 v[64:67], v6 offset:3072
    v_mfma_f32_16x16x32_bf16 v[128:131], v[36:39], v[68:71], v[128:131]
    buffer_load_dwordx4 v15, s[16:19], s55 offen offset:1024 lds
    v_mfma_f32_16x16x32_bf16 v[164:167], v[40:43], v[68:71], v[164:167]
    v_mfma_f32_16x16x32_bf16 v[200:203], v[44:47], v[68:71], v[200:203]
    v_mfma_f32_16x16x32_bf16 v[236:239], v[48:51], v[68:71], v[236:239]
    ds_read_b128 v[68:71], v6 offset:4096
    v_mfma_f32_16x16x32_bf16 v[132:135], v[36:39], v[72:75], v[132:135]
    v_mfma_f32_16x16x32_bf16 v[168:171], v[40:43], v[72:75], v[168:171]
    v_mfma_f32_16x16x32_bf16 v[204:207], v[44:47], v[72:75], v[204:207]
    v_mfma_f32_16x16x32_bf16 v[240:243], v[48:51], v[72:75], v[240:243]
    ds_read_b128 v[72:75], v6 offset:5120
    v_mfma_f32_16x16x32_bf16 v[136:139], v[36:39], v[76:79], v[136:139]
    buffer_load_dwordx4 v16, s[16:19], s55 offen offset:2048 lds
    v_mfma_f32_16x16x32_bf16 v[172:175], v[40:43], v[76:79], v[172:175]
    v_mfma_f32_16x16x32_bf16 v[208:211], v[44:47], v[76:79], v[208:211]
    v_mfma_f32_16x16x32_bf16 v[244:247], v[48:51], v[76:79], v[244:247]
    ds_read_b128 v[76:79], v6 offset:6144
    v_mfma_f32_16x16x32_bf16 v[140:143], v[36:39], v[80:83], v[140:143]
    v_mfma_f32_16x16x32_bf16 v[176:179], v[40:43], v[80:83], v[176:179]
    v_mfma_f32_16x16x32_bf16 v[212:215], v[44:47], v[80:83], v[212:215]
    v_mfma_f32_16x16x32_bf16 v[248:251], v[48:51], v[80:83], v[248:251]
    ds_read_b128 v[80:83], v6 offset:7168
    v_mfma_f32_16x16x32_bf16 v[144:147], v[84:87], v[36:39], v[144:147]
    buffer_load_dwordx4 v17, s[16:19], s55 offen offset:3072 lds
    s_add_u32 s55, s55, 128
    s_cmp_ge_u32 s55, 1152
    s_cselect_b32 s55, 0, s55
    v_mfma_f32_16x16x32_bf16 v[180:183], v[84:87], v[40:43], v[180:183]
    v_mfma_f32_16x16x32_bf16 v[216:219], v[84:87], v[44:47], v[216:219]
    v_mfma_f32_16x16x32_bf16 v[252:255], v[84:87], v[48:51], v[252:255]
    ds_read_b128 v[84:87], v6 offset:8192
    s_waitcnt lgkmcnt(8)
    v_mfma_f32_16x16x32_bf16 v[112:115], v[20:23], v[52:55], v[112:115]
    ds_read_b128 v[36:39], v3 offset:0
    v_mfma_f32_16x16x32_bf16 v[148:151], v[24:27], v[52:55], v[148:151]
    ds_read_b128 v[40:43], v3 offset:2048
    v_mfma_f32_16x16x32_bf16 v[184:187], v[28:31], v[52:55], v[184:187]
    ds_read_b128 v[44:47], v3 offset:4096
    v_mfma_f32_16x16x32_bf16 v[220:223], v[32:35], v[52:55], v[220:223]
    ds_read_b128 v[48:51], v3 offset:6144
    s_waitcnt lgkmcnt(11)
    v_mfma_f32_16x16x32_bf16 v[116:119], v[20:23], v[56:59], v[116:119]
    ds_read_b128 v[52:55], v6 offset:9216
    v_mfma_f32_16x16x32_bf16 v[152:155], v[24:27], v[56:59], v[152:155]
    s_add_u32 m0, s58, 65536
    s_nop 0
    buffer_load_dwordx4 v10, s[16:19], s55 offen offset:0 lds
    v_mfma_f32_16x16x32_bf16 v[188:191], v[28:31], v[56:59], v[188:191]
    v_mfma_f32_16x16x32_bf16 v[224:227], v[32:35], v[56:59], v[224:227]
    ds_read_b128 v[56:59], v6 offset:10240
    s_waitcnt lgkmcnt(12)
    v_mfma_f32_16x16x32_bf16 v[120:123], v[20:23], v[60:63], v[120:123]
    v_mfma_f32_16x16x32_bf16 v[156:159], v[24:27], v[60:63], v[156:159]
    v_mfma_f32_16x16x32_bf16 v[192:195], v[28:31], v[60:63], v[192:195]
    v_mfma_f32_16x16x32_bf16 v[228:231], v[32:35], v[60:63], v[228:231]
    ds_read_b128 v[60:63], v6 offset:11264
    s_waitcnt lgkmcnt(12)
    v_mfma_f32_16x16x32_bf16 v[124:127], v[20:23], v[64:67], v[124:127]
    v_mfma_f32_16x16x32_bf16 v[160:163], v[24:27], v[64:67], v[160:163]
    buffer_load_dwordx4 v11, s[16:19], s55 offen offset:1024 lds
    v_mfma_f32_16x16x32_bf16 v[196:199], v[28:31], v[64:67], v[196:199]
    v_mfma_f32_16x16x32_bf16 v[232:235], v[32:35], v[64:67], v[232:235]
    ds_read_b128 v[64:67], v6 offset:12288
    s_waitcnt lgkmcnt(12)
    v_mfma_f32_16x16x32_bf16 v[128:131], v[20:23], v[68:71], v[128:131]
    v_mfma_f32_16x16x32_bf16 v[164:167], v[24:27], v[68:71], v[164:167]
    v_mfma_f32_16x16x32_bf16 v[200:203], v[28:31], v[68:71], v[200:203]
    v_mfma_f32_16x16x32_bf16 v[236:239], v[32:35], v[68:71], v[236:239]
    ds_read_b128 v[68:71], v6 offset:13312
    s_waitcnt lgkmcnt(12)
    v_mfma_f32_16x16x32_bf16 v[132:135], v[20:23], v[72:75], v[132:135]
    v_mfma_f32_16x16x32_bf16 v[168:171], v[24:27], v[72:75], v[168:171]
    buffer_load_dwordx4 v12, s[16:19], s55 offen offset:2048 lds
    v_mfma_f32_16x16x32_bf16 v[204:207], v[28:31], v[72:75], v[204:207]
    v_mfma_f32_16x16x32_bf16 v[240:243], v[32:35], v[72:75], v[240:243]
    ds_read_b128 v[72:75], v6 offset:14336
    s_waitcnt lgkmcnt(12)
    v_mfma_f32_16x16x32_bf16 v[136:139], v[20:23], v[76:79], v[136:139]
    v_mfma_f32_16x16x32_bf16 v[172:175], v[24:27], v[76:79], v[172:175]
    v_mfma_f32_16x16x32_bf16 v[208:211], v[28:31], v[76:79], v[208:211]
    v_mfma_f32_16x16x32_bf16 v[244:247], v[32:35], v[76:79], v[244:247]
    ds_read_b128 v[76:79], v6 offset:15360
    s_waitcnt lgkmcnt(12)
    v_mfma_f32_16x16x32_bf16 v[140:143], v[20:23], v[80:83], v[140:143]
    v_mfma_f32_16x16x32_bf16 v[176:179], v[24:27], v[80:83], v[176:179]
    buffer_load_dwordx4 v13, s[16:19], s55 offen offset:3072 lds
    v_mfma_f32_16x16x32_bf16 v[212:215], v[28:31], v[80:83], v[212:215]
    v_mfma_f32_16x16x32_bf16 v[248:251], v[32:35], v[80:83], v[248:251]
    ds_read_b128 v[80:83], v6 offset:16384
    s_waitcnt lgkmcnt(12)
    v_mfma_f32_16x16x32_bf16 v[144:147], v[84:87], v[20:23], v[144:147]
    v_mfma_f32_16x16x32_bf16 v[180:183], v[84:87], v[24:27], v[180:183]
    v_mfma_f32_16x16x32_bf16 v[216:219], v[84:87], v[28:31], v[216:219]
    v_mfma_f32_16x16x32_bf16 v[252:255], v[84:87], v[32:35], v[252:255]
    ds_read_b128 v[84:87], v6 offset:17408
    s_waitcnt lgkmcnt(8)
    v_mfma_f32_16x16x32_bf16 v[112:115], v[36:39], v[52:55], v[112:115]
    v_mfma_f32_16x16x32_bf16 v[148:151], v[40:43], v[52:55], v[148:151]
    s_add_u32 m0, s58, 69632
    s_nop 0
    buffer_load_dwordx4 v14, s[16:19], s55 offen offset:0 lds
    v_mfma_f32_16x16x32_bf16 v[184:187], v[44:47], v[52:55], v[184:187]
    v_mfma_f32_16x16x32_bf16 v[220:223], v[48:51], v[52:55], v[220:223]
    s_waitcnt lgkmcnt(7)
    v_mfma_f32_16x16x32_bf16 v[116:119], v[36:39], v[56:59], v[116:119]
    v_mfma_f32_16x16x32_bf16 v[152:155], v[40:43], v[56:59], v[152:155]
    v_mfma_f32_16x16x32_bf16 v[188:191], v[44:47], v[56:59], v[188:191]
    v_mfma_f32_16x16x32_bf16 v[224:227], v[48:51], v[56:59], v[224:227]
    s_waitcnt vmcnt(5)
    s_waitcnt lgkmcnt(0)
    s_barrier
    v_mfma_f32_16x16x32_bf16 v[120:123], v[36:39], v[60:63], v[120:123]
    ds_read_b128 v[20:23], v2 offset:32768
    v_mfma_f32_16x16x32_bf16 v[156:159], v[40:43], v[60:63], v[156:159]
    ds_read_b128 v[24:27], v2 offset:34816
    v_mfma_f32_16x16x32_bf16 v[192:195], v[44:47], v[60:63], v[192:195]
    ds_read_b128 v[52:55], v6 offset:18432
    v_mfma_f32_16x16x32_bf16 v[228:231], v[48:51], v[60:63], v[228:231]
    ds_read_b128 v[56:59], v6 offset:19456
    v_mfma_f32_16x16x32_bf16 v[124:127], v[36:39], v[64:67], v[124:127]
    ds_read_b128 v[60:63], v6 offset:20480
    v_mfma_f32_16x16x32_bf16 v[160:163], v[40:43], v[64:67], v[160:163]
    buffer_load_dwordx4 v15, s[16:19], s55 offen offset:1024 lds
    v_mfma_f32_16x16x32_bf16 v[196:199], v[44:47], v[64:67], v[196:199]
    v_mfma_f32_16x16x32_bf16 v[232:235], v[48:51], v[64:67], v[232:235]
    ds_read_b128 v[64:67], v6 offset:21504
    v_mfma_f32_16x16x32_bf16 v[128:131], v[36:39], v[68:71], v[128:131]
    v_mfma_f32_16x16x32_bf16 v[164:167], v[40:43], v[68:71], v[164:167]
    v_mfma_f32_16x16x32_bf16 v[200:203], v[44:47], v[68:71], v[200:203]
    v_mfma_f32_16x16x32_bf16 v[236:239], v[48:51], v[68:71], v[236:239]
    ds_read_b128 v[68:71], v6 offset:22528
    v_mfma_f32_16x16x32_bf16 v[132:135], v[36:39], v[72:75], v[132:135]
    v_mfma_f32_16x16x32_bf16 v[168:171], v[40:43], v[72:75], v[168:171]
    buffer_load_dwordx4 v16, s[16:19], s55 offen offset:2048 lds
    v_mfma_f32_16x16x32_bf16 v[204:207], v[44:47], v[72:75], v[204:207]
    v_mfma_f32_16x16x32_bf16 v[240:243], v[48:51], v[72:75], v[240:243]
    ds_read_b128 v[72:75], v6 offset:23552
    v_mfma_f32_16x16x32_bf16 v[136:139], v[36:39], v[76:79], v[136:139]
    v_mfma_f32_16x16x32_bf16 v[172:175], v[40:43], v[76:79], v[172:175]
    v_mfma_f32_16x16x32_bf16 v[208:211], v[44:47], v[76:79], v[208:211]
    v_mfma_f32_16x16x32_bf16 v[244:247], v[48:51], v[76:79], v[244:247]
    ds_read_b128 v[76:79], v6 offset:24576
    v_mfma_f32_16x16x32_bf16 v[140:143], v[36:39], v[80:83], v[140:143]
    v_mfma_f32_16x16x32_bf16 v[176:179], v[40:43], v[80:83], v[176:179]
    buffer_load_dwordx4 v17, s[16:19], s55 offen offset:3072 lds
    s_add_u32 s55, s55, 128
    s_cmp_ge_u32 s55, 1152
    s_cselect_b32 s55, 0, s55
    v_mfma_f32_16x16x32_bf16 v[212:215], v[44:47], v[80:83], v[212:215]
    v_mfma_f32_16x16x32_bf16 v[248:251], v[48:51], v[80:83], v[248:251]
    ds_read_b128 v[80:83], v6 offset:25600
    v_mfma_f32_16x16x32_bf16 v[144:147], v[84:87], v[36:39], v[144:147]
    v_mfma_f32_16x16x32_bf16 v[180:183], v[84:87], v[40:43], v[180:183]
    v_mfma_f32_16x16x32_bf16 v[216:219], v[84:87], v[44:47], v[216:219]
    v_mfma_f32_16x16x32_bf16 v[252:255], v[84:87], v[48:51], v[252:255]
    ds_read_b128 v[84:87], v6 offset:26624
    s_waitcnt lgkmcnt(8)
    v_mfma_f32_16x16x32_bf16 v[112:115], v[20:23], v[52:55], v[112:115]
    ds_read_b128 v[36:39], v3 offset:32768
    v_mfma_f32_16x16x32_bf16 v[148:151], v[24:27], v[52:55], v[148:151]
    ds_read_b128 v[40:43], v3 offset:34816
    s_waitcnt lgkmcnt(9)
    v_mfma_f32_16x16x32_bf16 v[116:119], v[20:23], v[56:59], v[116:119]
    ds_read_b128 v[52:55], v6 offset:27648
    v_mfma_f32_16x16x32_bf16 v[152:155], v[24:27], v[56:59], v[152:155]
    ds_read_b128 v[56:59], v6 offset:28672
    s_waitcnt lgkmcnt(10)
    v_mfma_f32_16x16x32_bf16 v[120:123], v[20:23], v[60:63], v[120:123]
    v_mfma_f32_16x16x32_bf16 v[156:159], v[24:27], v[60:63], v[156:159]
    ds_read_b128 v[60:63], v6 offset:29696
    s_waitcnt lgkmcnt(10)
    v_mfma_f32_16x16x32_bf16 v[124:127], v[20:23], v[64:67], v[124:127]
    v_mfma_f32_16x16x32_bf16 v[160:163], v[24:27], v[64:67], v[160:163]
    ds_read_b128 v[64:67], v6 offset:30720
    s_waitcnt lgkmcnt(10)
    v_mfma_f32_16x16x32_bf16 v[128:131], v[20:23], v[68:71], v[128:131]
    v_mfma_f32_16x16x32_bf16 v[164:167], v[24:27], v[68:71], v[164:167]
    ds_read_b128 v[68:71], v6 offset:31744
    s_waitcnt lgkmcnt(10)
    v_mfma_f32_16x16x32_bf16 v[132:135], v[20:23], v[72:75], v[132:135]
    v_mfma_f32_16x16x32_bf16 v[168:171], v[24:27], v[72:75], v[168:171]
    ds_read_b128 v[72:75], v6 offset:32768
    s_waitcnt lgkmcnt(10)
    v_mfma_f32_16x16x32_bf16 v[136:139], v[20:23], v[76:79], v[136:139]
    v_mfma_f32_16x16x32_bf16 v[172:175], v[24:27], v[76:79], v[172:175]
    ds_read_b128 v[76:79], v6 offset:33792
    s_waitcnt lgkmcnt(10)
    v_mfma_f32_16x16x32_bf16 v[140:143], v[20:23], v[80:83], v[140:143]
    v_mfma_f32_16x16x32_bf16 v[176:179], v[24:27], v[80:83], v[176:179]
    ds_read_b128 v[80:83], v6 offset:34816
    s_waitcnt lgkmcnt(10)
    v_mfma_f32_16x16x32_bf16 v[144:147], v[84:87], v[20:23], v[144:147]
    v_mfma_f32_16x16x32_bf16 v[180:183], v[84:87], v[24:27], v[180:183]
    ds_read_b128 v[84:87], v6 offset:35840
    s_waitcnt lgkmcnt(8)
    v_mfma_f32_16x16x32_bf16 v[112:115], v[36:39], v[52:55], v[112:115]
    v_mfma_f32_16x16x32_bf16 v[148:151], v[40:43], v[52:55], v[148:151]
    s_waitcnt lgkmcnt(7)
    v_mfma_f32_16x16x32_bf16 v[116:119], v[36:39], v[56:59], v[116:119]
    v_mfma_f32_16x16x32_bf16 v[152:155], v[40:43], v[56:59], v[152:155]
    s_waitcnt lgkmcnt(6)
    v_mfma_f32_16x16x32_bf16 v[120:123], v[36:39], v[60:63], v[120:123]
    v_mfma_f32_16x16x32_bf16 v[156:159], v[40:43], v[60:63], v[156:159]
    s_waitcnt lgkmcnt(5)
    v_mfma_f32_16x16x32_bf16 v[124:127], v[36:39], v[64:67], v[124:127]
    v_mfma_f32_16x16x32_bf16 v[160:163], v[40:43], v[64:67], v[160:163]
    s_waitcnt lgkmcnt(4)
    v_mfma_f32_16x16x32_bf16 v[128:131], v[36:39], v[68:71], v[128:131]
    v_mfma_f32_16x16x32_bf16 v[164:167], v[40:43], v[68:71], v[164:167]
    s_waitcnt lgkmcnt(3)
    v_mfma_f32_16x16x32_bf16 v[132:135], v[36:39], v[72:75], v[132:135]
    v_mfma_f32_16x16x32_bf16 v[168:171], v[40:43], v[72:75], v[168:171]
    s_waitcnt vmcnt(0)
    s_waitcnt lgkmcnt(0)
    s_barrier
    v_mfma_f32_16x16x32_bf16 v[136:139], v[36:39], v[76:79], v[136:139]
    ds_read_b128 v[20:23], v4 offset:0
    v_mfma_f32_16x16x32_bf16 v[172:175], v[40:43], v[76:79], v[172:175]
    ds_read_b128 v[24:27], v4 offset:2048
    v_mfma_f32_16x16x32_bf16 v[140:143], v[36:39], v[80:83], v[140:143]
    ds_read_b128 v[52:55], v6 offset:0
    v_mfma_f32_16x16x32_bf16 v[176:179], v[40:43], v[80:83], v[176:179]
    ds_read_b128 v[56:59], v6 offset:1024
    v_mfma_f32_16x16x32_bf16 v[144:147], v[84:87], v[36:39], v[144:147]
    ds_read_b128 v[60:63], v6 offset:2048
    v_mfma_f32_16x16x32_bf16 v[180:183], v[84:87], v[40:43], v[180:183]
    ds_read_b128 v[64:67], v6 offset:3072
    s_waitcnt lgkmcnt(3)
    v_mfma_f32_16x16x32_bf16 v[112:115], v[20:23], v[52:55], v[112:115]
    ds_read_b128 v[68:71], v6 offset:4096
    v_mfma_f32_16x16x32_bf16 v[148:151], v[24:27], v[52:55], v[148:151]
    ds_read_b128 v[72:75], v6 offset:5120
    s_waitcnt lgkmcnt(4)
    v_mfma_f32_16x16x32_bf16 v[116:119], v[20:23], v[56:59], v[116:119]
    ds_read_b128 v[76:79], v6 offset:6144
    v_mfma_f32_16x16x32_bf16 v[152:155], v[24:27], v[56:59], v[152:155]
    ds_read_b128 v[80:83], v6 offset:7168
    s_waitcnt lgkmcnt(5)
    v_mfma_f32_16x16x32_bf16 v[120:123], v[20:23], v[60:63], v[120:123]
    ds_read_b128 v[84:87], v6 offset:8192
    v_mfma_f32_16x16x32_bf16 v[156:159], v[24:27], v[60:63], v[156:159]
    ds_read_b128 v[36:39], v5 offset:0
    s_waitcnt lgkmcnt(6)
    v_mfma_f32_16x16x32_bf16 v[124:127], v[20:23], v[64:67], v[124:127]
    ds_read_b128 v[40:43], v5 offset:2048
    v_mfma_f32_16x16x32_bf16 v[160:163], v[24:27], v[64:67], v[160:163]
    ds_read_b128 v[52:55], v6 offset:9216
    s_waitcnt lgkmcnt(7)
    v_mfma_f32_16x16x32_bf16 v[128:131], v[20:23], v[68:71], v[128:131]
    ds_read_b128 v[56:59], v6 offset:10240
    v_mfma_f32_16x16x32_bf16 v[164:167], v[24:27], v[68:71], v[164:167]
    ds_read_b128 v[60:63], v6 offset:11264
    s_waitcnt lgkmcnt(8)
    v_mfma_f32_16x16x32_bf16 v[132:135], v[20:23], v[72:75], v[132:135]
    ds_read_b128 v[64:67], v6 offset:12288
    v_mfma_f32_16x16x32_bf16 v[168:171], v[24:27], v[72:75], v[168:171]
    ds_read_b128 v[68:71], v6 offset:13312
    s_waitcnt lgkmcnt(9)
    v_mfma_f32_16x16x32_bf16 v[136:139], v[20:23], v[76:79], v[136:139]
    ds_read_b128 v[72:75], v6 offset:14336
    v_mfma_f32_16x16x32_bf16 v[172:175], v[24:27], v[76:79], v[172:175]
    ds_read_b128 v[76:79], v6 offset:15360
    s_waitcnt lgkmcnt(10)
    v_mfma_f32_16x16x32_bf16 v[140:143], v[20:23], v[80:83], v[140:143]
    v_mfma_f32_16x16x32_bf16 v[176:179], v[24:27], v[80:83], v[176:179]
    ds_read_b128 v[80:83], v6 offset:16384
    s_waitcnt lgkmcnt(10)
    v_mfma_f32_16x16x32_bf16 v[144:147], v[84:87], v[20:23], v[144:147]
    v_mfma_f32_16x16x32_bf16 v[180:183], v[84:87], v[24:27], v[180:183]
    ds_read_b128 v[84:87], v6 offset:17408
    s_waitcnt lgkmcnt(8)
    v_mfma_f32_16x16x32_bf16 v[112:115], v[36:39], v[52:55], v[112:115]
    ds_read_b128 v[28:31], v2 offset:36864
    v_mfma_f32_16x16x32_bf16 v[148:151], v[40:43], v[52:55], v[148:151]
    ds_read_b128 v[32:35], v2 offset:38912
    s_waitcnt lgkmcnt(9)
    v_mfma_f32_16x16x32_bf16 v[116:119], v[36:39], v[56:59], v[116:119]
    ds_read_b128 v[52:55], v6 offset:18432
    v_mfma_f32_16x16x32_bf16 v[152:155], v[40:43], v[56:59], v[152:155]
    ds_read_b128 v[56:59], v6 offset:19456
    s_waitcnt lgkmcnt(10)
    v_mfma_f32_16x16x32_bf16 v[120:123], v[36:39], v[60:63], v[120:123]
    v_mfma_f32_16x16x32_bf16 v[156:159], v[40:43], v[60:63], v[156:159]
    ds_read_b128 v[60:63], v6 offset:20480
    s_waitcnt lgkmcnt(10)
    v_mfma_f32_16x16x32_bf16 v[124:127], v[36:39], v[64:67], v[124:127]
    v_mfma_f32_16x16x32_bf16 v[160:163], v[40:43], v[64:67], v[160:163]
    ds_read_b128 v[64:67], v6 offset:21504
    s_waitcnt lgkmcnt(10)
    v_mfma_f32_16x16x32_bf16 v[128:131], v[36:39], v[68:71], v[128:131]
    v_mfma_f32_16x16x32_bf16 v[164:167], v[40:43], v[68:71], v[164:167]
    ds_read_b128 v[68:71], v6 offset:22528
    s_waitcnt lgkmcnt(10)
    v_mfma_f32_16x16x32_bf16 v[132:135], v[36:39], v[72:75], v[132:135]
    v_mfma_f32_16x16x32_bf16 v[168:171], v[40:43], v[72:75], v[168:171]
    ds_read_b128 v[72:75], v6 offset:23552
    s_waitcnt lgkmcnt(10)
    v_mfma_f32_16x16x32_bf16 v[136:139], v[36:39], v[76:79], v[136:139]
    v_mfma_f32_16x16x32_bf16 v[172:175], v[40:43], v[76:79], v[172:175]
    ds_read_b128 v[76:79], v6 offset:24576
    s_waitcnt lgkmcnt(10)
    v_mfma_f32_16x16x32_bf16 v[140:143], v[36:39], v[80:83], v[140:143]
    v_mfma_f32_16x16x32_bf16 v[176:179], v[40:43], v[80:83], v[176:179]
    ds_read_b128 v[80:83], v6 offset:25600
    s_waitcnt lgkmcnt(10)
    v_mfma_f32_16x16x32_bf16 v[144:147], v[84:87], v[36:39], v[144:147]
    v_mfma_f32_16x16x32_bf16 v[180:183], v[84:87], v[40:43], v[180:183]
    ds_read_b128 v[84:87], v6 offset:26624
    s_waitcnt lgkmcnt(8)
    v_mfma_f32_16x16x32_bf16 v[184:187], v[28:31], v[52:55], v[184:187]
    ds_read_b128 v[44:47], v3 offset:36864
    v_mfma_f32_16x16x32_bf16 v[220:223], v[32:35], v[52:55], v[220:223]
    ds_read_b128 v[48:51], v3 offset:38912
    s_waitcnt lgkmcnt(9)
    v_mfma_f32_16x16x32_bf16 v[188:191], v[28:31], v[56:59], v[188:191]
    ds_read_b128 v[52:55], v6 offset:27648
    v_mfma_f32_16x16x32_bf16 v[224:227], v[32:35], v[56:59], v[224:227]
    ds_read_b128 v[56:59], v6 offset:28672
    s_waitcnt lgkmcnt(10)
    v_mfma_f32_16x16x32_bf16 v[192:195], v[28:31], v[60:63], v[192:195]
    v_mfma_f32_16x16x32_bf16 v[228:231], v[32:35], v[60:63], v[228:231]
    ds_read_b128 v[60:63], v6 offset:29696
    s_waitcnt lgkmcnt(10)
    v_mfma_f32_16x16x32_bf16 v[196:199], v[28:31], v[64:67], v[196:199]
    v_cvt_pk_bf16_f32 v88, v112, v116
    v_cvt_pk_bf16_f32 v89, v120, v124
    v_cvt_pk_bf16_f32 v90, v128, v132
    v_mfma_f32_16x16x32_bf16 v[232:235], v[32:35], v[64:67], v[232:235]
    ds_read_b128 v[64:67], v6 offset:30720
    v_cvt_pk_bf16_f32 v91, v136, v140
    s_mov_b32 s53, 0
    buffer_store_dwordx4 v[88:91], v7, s[32:35], s53 offen sc1 nt
    v_cvt_pk_bf16_f32 v94, v113, v117
    s_waitcnt lgkmcnt(10)
    v_mfma_f32_16x16x32_bf16 v[200:203], v[28:31], v[68:71], v[200:203]
    v_cvt_pk_bf16_f32 v95, v121, v125
    v_cvt_pk_bf16_f32 v96, v129, v133
    v_cvt_pk_bf16_f32 v97, v137, v141
    v_mfma_f32_16x16x32_bf16 v[236:239], v[32:35], v[68:71], v[236:239]
    ds_read_b128 v[68:71], v6 offset:31744
    s_mov_b32 s53, 9216
    buffer_store_dwordx4 v[94:97], v7, s[32:35], s53 offen sc1 nt
    v_cvt_pk_bf16_f32 v100, v114, v118
    v_cvt_pk_bf16_f32 v101, v122, v126
    s_waitcnt lgkmcnt(10)
    v_mfma_f32_16x16x32_bf16 v[204:207], v[28:31], v[72:75], v[204:207]
    v_cvt_pk_bf16_f32 v102, v130, v134
    v_cvt_pk_bf16_f32 v103, v138, v142
    s_mov_b32 s53, 18432
    buffer_store_dwordx4 v[100:103], v7, s[32:35], s53 offen sc1 nt
    v_mfma_f32_16x16x32_bf16 v[240:243], v[32:35], v[72:75], v[240:243]
    ds_read_b128 v[72:75], v6 offset:32768
    v_cvt_pk_bf16_f32 v88, v115, v119
    v_cvt_pk_bf16_f32 v89, v123, v127
    v_cvt_pk_bf16_f32 v90, v131, v135
    s_waitcnt lgkmcnt(10)
    v_mfma_f32_16x16x32_bf16 v[208:211], v[28:31], v[76:79], v[208:211]
    v_cvt_pk_bf16_f32 v91, v139, v143
    s_mov_b32 s53, 27648
    buffer_store_dwordx4 v[88:91], v7, s[32:35], s53 offen sc1 nt
    v_cvt_pk_bf16_f32 v94, v144, v145
    v_mfma_f32_16x16x32_bf16 v[244:247], v[32:35], v[76:79], v[244:247]
    ds_read_b128 v[76:79], v6 offset:33792
    v_cvt_pk_bf16_f32 v95, v146, v147
    s_mov_b32 s53, 0
    buffer_store_dwordx2 v[94:95], v8, s[32:35], s53 offen
    v_cvt_pk_bf16_f32 v100, v148, v152
    s_waitcnt lgkmcnt(10)
    v_mfma_f32_16x16x32_bf16 v[212:215], v[28:31], v[80:83], v[212:215]
    v_cvt_pk_bf16_f32 v101, v156, v160
    v_cvt_pk_bf16_f32 v102, v164, v168
    v_cvt_pk_bf16_f32 v103, v172, v176
    v_mfma_f32_16x16x32_bf16 v[248:251], v[32:35], v[80:83], v[248:251]
    ds_read_b128 v[80:83], v6 offset:34816
    s_mov_b32 s53, 147456
    buffer_store_dwordx4 v[100:103], v7, s[32:35], s53 offen sc1 nt
    v_cvt_pk_bf16_f32 v88, v149, v153
    v_cvt_pk_bf16_f32 v89, v157, v161
    s_waitcnt lgkmcnt(10)
    v_mfma_f32_16x16x32_bf16 v[216:219], v[84:87], v[28:31], v[216:219]
    v_cvt_pk_bf16_f32 v90, v165, v169
    v_cvt_pk_bf16_f32 v91, v173, v177
    s_mov_b32 s53, 156672
    buffer_store_dwordx4 v[88:91], v7, s[32:35], s53 offen sc1 nt
    v_mfma_f32_16x16x32_bf16 v[252:255], v[84:87], v[32:35], v[252:255]
    ds_read_b128 v[84:87], v6 offset:35840
    v_cvt_pk_bf16_f32 v94, v150, v154
    v_cvt_pk_bf16_f32 v95, v158, v162
    v_cvt_pk_bf16_f32 v96, v166, v170
    s_waitcnt lgkmcnt(8)
    v_mfma_f32_16x16x32_bf16 v[184:187], v[44:47], v[52:55], v[184:187]
    ds_read_b128 v[28:31], v4 offset:4096
    v_cvt_pk_bf16_f32 v97, v174, v178
    s_mov_b32 s53, 165888
    buffer_store_dwordx4 v[94:97], v7, s[32:35], s53 offen sc1 nt
    v_cvt_pk_bf16_f32 v100, v151, v155
    v_mfma_f32_16x16x32_bf16 v[220:223], v[48:51], v[52:55], v[220:223]
    ds_read_b128 v[32:35], v4 offset:6144
    v_cvt_pk_bf16_f32 v101, v159, v163
    v_cvt_pk_bf16_f32 v102, v167, v171
    v_cvt_pk_bf16_f32 v103, v175, v179
    s_waitcnt lgkmcnt(9)
    v_mfma_f32_16x16x32_bf16 v[188:191], v[44:47], v[56:59], v[188:191]
    ds_read_b128 v[52:55], v6 offset:0
    s_mov_b32 s53, 175104
    buffer_store_dwordx4 v[100:103], v7, s[32:35], s53 offen sc1 nt
    v_cvt_pk_bf16_f32 v88, v180, v181
    v_cvt_pk_bf16_f32 v89, v182, v183
    v_mfma_f32_16x16x32_bf16 v[224:227], v[48:51], v[56:59], v[224:227]
    ds_read_b128 v[56:59], v6 offset:1024
    s_mov_b32 s53, 147456
    buffer_store_dwordx2 v[88:89], v8, s[32:35], s53 offen
    s_waitcnt lgkmcnt(10)
    v_mfma_f32_16x16x32_bf16 v[192:195], v[44:47], v[60:63], v[192:195]
    v_mfma_f32_16x16x32_bf16 v[228:231], v[48:51], v[60:63], v[228:231]
    ds_read_b128 v[60:63], v6 offset:2048
    s_waitcnt lgkmcnt(10)
    v_mfma_f32_16x16x32_bf16 v[196:199], v[44:47], v[64:67], v[196:199]
    v_mfma_f32_16x16x32_bf16 v[232:235], v[48:51], v[64:67], v[232:235]
    ds_read_b128 v[64:67], v6 offset:3072
    s_waitcnt lgkmcnt(10)
    v_mfma_f32_16x16x32_bf16 v[200:203], v[44:47], v[68:71], v[200:203]
    v_mfma_f32_16x16x32_bf16 v[236:239], v[48:51], v[68:71], v[236:239]
    ds_read_b128 v[68:71], v6 offset:4096
    s_waitcnt lgkmcnt(10)
    v_mfma_f32_16x16x32_bf16 v[204:207], v[44:47], v[72:75], v[204:207]
    v_mfma_f32_16x16x32_bf16 v[240:243], v[48:51], v[72:75], v[240:243]
    ds_read_b128 v[72:75], v6 offset:5120
    s_waitcnt lgkmcnt(10)
    v_mfma_f32_16x16x32_bf16 v[208:211], v[44:47], v[76:79], v[208:211]
    v_mfma_f32_16x16x32_bf16 v[244:247], v[48:51], v[76:79], v[244:247]
    ds_read_b128 v[76:79], v6 offset:6144
    s_waitcnt lgkmcnt(10)
    v_mfma_f32_16x16x32_bf16 v[212:215], v[44:47], v[80:83], v[212:215]
    v_mfma_f32_16x16x32_bf16 v[248:251], v[48:51], v[80:83], v[248:251]
    ds_read_b128 v[80:83], v6 offset:7168
    s_waitcnt lgkmcnt(10)
    v_mfma_f32_16x16x32_bf16 v[216:219], v[84:87], v[44:47], v[216:219]
    v_mfma_f32_16x16x32_bf16 v[252:255], v[84:87], v[48:51], v[252:255]
    ds_read_b128 v[84:87], v6 offset:8192
    s_waitcnt lgkmcnt(8)
    v_mfma_f32_16x16x32_bf16 v[184:187], v[28:31], v[52:55], v[184:187]
    ds_read_b128 v[44:47], v5 offset:4096
    v_mfma_f32_16x16x32_bf16 v[220:223], v[32:35], v[52:55], v[220:223]
    ds_read_b128 v[48:51], v5 offset:6144
    s_waitcnt lgkmcnt(9)
    v_mfma_f32_16x16x32_bf16 v[188:191], v[28:31], v[56:59], v[188:191]
    ds_read_b128 v[52:55], v6 offset:9216
    v_mfma_f32_16x16x32_bf16 v[224:227], v[32:35], v[56:59], v[224:227]
    ds_read_b128 v[56:59], v6 offset:10240
    s_waitcnt lgkmcnt(10)
    v_mfma_f32_16x16x32_bf16 v[192:195], v[28:31], v[60:63], v[192:195]
    v_mfma_f32_16x16x32_bf16 v[228:231], v[32:35], v[60:63], v[228:231]
    ds_read_b128 v[60:63], v6 offset:11264
    s_waitcnt lgkmcnt(10)
    v_mfma_f32_16x16x32_bf16 v[196:199], v[28:31], v[64:67], v[196:199]
    v_mfma_f32_16x16x32_bf16 v[232:235], v[32:35], v[64:67], v[232:235]
    ds_read_b128 v[64:67], v6 offset:12288
    s_waitcnt lgkmcnt(10)
    v_mfma_f32_16x16x32_bf16 v[200:203], v[28:31], v[68:71], v[200:203]
    v_mfma_f32_16x16x32_bf16 v[236:239], v[32:35], v[68:71], v[236:239]
    ds_read_b128 v[68:71], v6 offset:13312
    s_waitcnt lgkmcnt(10)
    v_mfma_f32_16x16x32_bf16 v[204:207], v[28:31], v[72:75], v[204:207]
    v_mfma_f32_16x16x32_bf16 v[240:243], v[32:35], v[72:75], v[240:243]
    ds_read_b128 v[72:75], v6 offset:14336
    s_waitcnt lgkmcnt(10)
    v_mfma_f32_16x16x32_bf16 v[208:211], v[28:31], v[76:79], v[208:211]
    v_mfma_f32_16x16x32_bf16 v[244:247], v[32:35], v[76:79], v[244:247]
    ds_read_b128 v[76:79], v6 offset:15360
    s_waitcnt lgkmcnt(10)
    v_mfma_f32_16x16x32_bf16 v[212:215], v[28:31], v[80:83], v[212:215]
    v_mfma_f32_16x16x32_bf16 v[248:251], v[32:35], v[80:83], v[248:251]
    ds_read_b128 v[80:83], v6 offset:16384
    s_waitcnt lgkmcnt(10)
    v_mfma_f32_16x16x32_bf16 v[216:219], v[84:87], v[28:31], v[216:219]
    v_mfma_f32_16x16x32_bf16 v[252:255], v[84:87], v[32:35], v[252:255]
    ds_read_b128 v[84:87], v6 offset:17408
    s_waitcnt lgkmcnt(0)
    v_mfma_f32_16x16x32_bf16 v[184:187], v[44:47], v[52:55], v[184:187]
    v_mfma_f32_16x16x32_bf16 v[188:191], v[44:47], v[56:59], v[188:191]
    v_mfma_f32_16x16x32_bf16 v[192:195], v[44:47], v[60:63], v[192:195]
    v_mfma_f32_16x16x32_bf16 v[196:199], v[44:47], v[64:67], v[196:199]
    v_mfma_f32_16x16x32_bf16 v[200:203], v[44:47], v[68:71], v[200:203]
    v_mfma_f32_16x16x32_bf16 v[204:207], v[44:47], v[72:75], v[204:207]
    v_mfma_f32_16x16x32_bf16 v[208:211], v[44:47], v[76:79], v[208:211]
    v_mfma_f32_16x16x32_bf16 v[212:215], v[44:47], v[80:83], v[212:215]
    v_mfma_f32_16x16x32_bf16 v[216:219], v[84:87], v[44:47], v[216:219]
    v_mfma_f32_16x16x32_bf16 v[220:223], v[48:51], v[52:55], v[220:223]
    v_mfma_f32_16x16x32_bf16 v[224:227], v[48:51], v[56:59], v[224:227]
    v_mfma_f32_16x16x32_bf16 v[228:231], v[48:51], v[60:63], v[228:231]
    v_mfma_f32_16x16x32_bf16 v[232:235], v[48:51], v[64:67], v[232:235]
    v_mfma_f32_16x16x32_bf16 v[236:239], v[48:51], v[68:71], v[236:239]
    v_mfma_f32_16x16x32_bf16 v[240:243], v[48:51], v[72:75], v[240:243]
    v_mfma_f32_16x16x32_bf16 v[244:247], v[48:51], v[76:79], v[244:247]
    v_mfma_f32_16x16x32_bf16 v[248:251], v[48:51], v[80:83], v[248:251]
    v_mfma_f32_16x16x32_bf16 v[252:255], v[84:87], v[48:51], v[252:255]
    v_cvt_pk_bf16_f32 v94, v184, v188
    v_cvt_pk_bf16_f32 v95, v192, v196
    v_cvt_pk_bf16_f32 v96, v200, v204
    v_cvt_pk_bf16_f32 v97, v208, v212
    s_mov_b32 s53, 294912
    buffer_store_dwordx4 v[94:97], v7, s[32:35], s53 offen sc1 nt
    v_cvt_pk_bf16_f32 v100, v185, v189
    v_cvt_pk_bf16_f32 v101, v193, v197
    v_cvt_pk_bf16_f32 v102, v201, v205
    v_cvt_pk_bf16_f32 v103, v209, v213
    s_mov_b32 s53, 304128
    buffer_store_dwordx4 v[100:103], v7, s[32:35], s53 offen sc1 nt
    v_cvt_pk_bf16_f32 v88, v186, v190
    v_cvt_pk_bf16_f32 v89, v194, v198
    v_cvt_pk_bf16_f32 v90, v202, v206
    v_cvt_pk_bf16_f32 v91, v210, v214
    s_mov_b32 s53, 313344
    buffer_store_dwordx4 v[88:91], v7, s[32:35], s53 offen sc1 nt
    v_cvt_pk_bf16_f32 v94, v187, v191
    v_cvt_pk_bf16_f32 v95, v195, v199
    v_cvt_pk_bf16_f32 v96, v203, v207
    v_cvt_pk_bf16_f32 v97, v211, v215
    s_mov_b32 s53, 322560
    buffer_store_dwordx4 v[94:97], v7, s[32:35], s53 offen sc1 nt
    v_cvt_pk_bf16_f32 v100, v216, v217
    v_cvt_pk_bf16_f32 v101, v218, v219
    s_mov_b32 s53, 294912
    buffer_store_dwordx2 v[100:101], v8, s[32:35], s53 offen
    s_nop 7
    v_cvt_pk_bf16_f32 v88, v220, v224
    v_cvt_pk_bf16_f32 v89, v228, v232
    v_cvt_pk_bf16_f32 v90, v236, v240
    v_cvt_pk_bf16_f32 v91, v244, v248
    s_mov_b32 s53, 442368
    buffer_store_dwordx4 v[88:91], v7, s[32:35], s53 offen sc1 nt
    v_cvt_pk_bf16_f32 v94, v221, v225
    v_cvt_pk_bf16_f32 v95, v229, v233
    v_cvt_pk_bf16_f32 v96, v237, v241
    v_cvt_pk_bf16_f32 v97, v245, v249
    s_mov_b32 s53, 451584
    buffer_store_dwordx4 v[94:97], v7, s[32:35], s53 offen sc1 nt
    v_cvt_pk_bf16_f32 v100, v222, v226
    v_cvt_pk_bf16_f32 v101, v230, v234
    v_cvt_pk_bf16_f32 v102, v238, v242
    v_cvt_pk_bf16_f32 v103, v246, v250
    s_mov_b32 s53, 460800
    buffer_store_dwordx4 v[100:103], v7, s[32:35], s53 offen sc1 nt
    v_cvt_pk_bf16_f32 v88, v223, v227
    v_cvt_pk_bf16_f32 v89, v231, v235
    v_cvt_pk_bf16_f32 v90, v239, v243
    v_cvt_pk_bf16_f32 v91, v247, v251
    s_mov_b32 s53, 470016
    buffer_store_dwordx4 v[88:91], v7, s[32:35], s53 offen sc1 nt
    v_cvt_pk_bf16_f32 v94, v252, v253
    v_cvt_pk_bf16_f32 v95, v254, v255
    s_mov_b32 s53, 442368
    buffer_store_dwordx2 v[94:95], v8, s[32:35], s53 offen
    s_endpgm
L_prod:
    s_and_b32 s50, s49, 1
    s_lshl_b32 s50, s50, 2
    s_lshr_b32 s53, s49, 1
    s_lshl_b32 s52, s53, 5
    s_add_u32 s50, s50, s52
    v_lshl_add_u32 v206, v201, 3, s50
    v_mul_u32_u24 v206, 18432, v206
    v_lshl_add_u32 v2, v67, 2, v206
    v_lshl_add_u32 v6, v68, 2, v206
    v_add_u32 v3, 18432, v2
    v_add_u32 v7, 18432, v6
    v_add_u32 v4, 36864, v2
    v_add_u32 v8, 36864, v6
    v_add_u32 v5, 55296, v2
    v_add_u32 v9, 55296, v6
    s_mul_i32 s54, s43, 1179648
    s_add_u32 s51, s51, s53
    s_mul_i32 s56, s51, 9216
    v_lshlrev_b32 v69, 1, v67
    v_lshlrev_b32 v70, 1, v68
    s_waitcnt lgkmcnt(0)
    s_mov_b32 s24, s8
    s_and_b32 s25, s9, 0xffff
    s_mov_b32 s26, 165888
    s_mov_b32 s27, 0x20000
    s_mov_b32 s28, s10
    s_and_b32 s29, s11, 0xffff
    s_mov_b32 s30, 165888
    s_mov_b32 s31, 0x20000
    buffer_load_dwordx4 v[220:223], v69, s[24:27], s56 offen
    buffer_load_dwordx4 v[224:227], v69, s[28:31], s56 offen
    buffer_load_ushort v228, v70, s[24:27], s56 offen
    buffer_load_ushort v229, v70, s[28:31], s56 offen
    s_mov_b32 s20, s6
    s_and_b32 s21, s7, 0xffff
    s_mov_b32 s22, 10616832
    s_mov_b32 s23, 0x20000
    buffer_load_dwordx4 v[76:79], v2, s[20:23], s54 offen
    buffer_load_dwordx4 v[80:83], v2, s[20:23], s54 offen offset:16
    buffer_load_dword v108, v6, s[20:23], s54 offen
    buffer_load_dwordx4 v[84:87], v3, s[20:23], s54 offen
    buffer_load_dwordx4 v[88:91], v3, s[20:23], s54 offen offset:16
    buffer_load_dword v109, v7, s[20:23], s54 offen
    buffer_load_dwordx4 v[92:95], v4, s[20:23], s54 offen
    buffer_load_dwordx4 v[96:99], v4, s[20:23], s54 offen offset:16
    buffer_load_dword v110, v8, s[20:23], s54 offen
    buffer_load_dwordx4 v[100:103], v5, s[20:23], s54 offen
    buffer_load_dwordx4 v[104:107], v5, s[20:23], s54 offen offset:16
    buffer_load_dword v111, v9, s[20:23], s54 offen
    s_add_u32 s54, s54, 1179648
    s_cmp_ge_u32 s54, 10616832
    s_cselect_b32 s54, 0, s54
    buffer_load_dwordx4 v[112:115], v2, s[20:23], s54 offen
    buffer_load_dwordx4 v[116:119], v2, s[20:23], s54 offen offset:16
    buffer_load_dword v144, v6, s[20:23], s54 offen
    buffer_load_dwordx4 v[120:123], v3, s[20:23], s54 offen
    buffer_load_dwordx4 v[124:127], v3, s[20:23], s54 offen offset:16
    buffer_load_dword v145, v7, s[20:23], s54 offen
    buffer_load_dwordx4 v[128:131], v4, s[20:23], s54 offen
    buffer_load_dwordx4 v[132:135], v4, s[20:23], s54 offen offset:16
    buffer_load_dword v146, v8, s[20:23], s54 offen
    buffer_load_dwordx4 v[136:139], v5, s[20:23], s54 offen
    buffer_load_dwordx4 v[140:143], v5, s[20:23], s54 offen offset:16
    buffer_load_dword v147, v9, s[20:23], s54 offen
    s_add_u32 s54, s54, 1179648
    s_cmp_ge_u32 s54, 10616832
    s_cselect_b32 s54, 0, s54
    s_mul_i32 s52, s53, 9216
    s_and_b32 s50, s49, 1
    s_lshl_b32 s50, s50, 3
    s_add_u32 s52, s52, s50
    s_add_u32 s52, s52, 98304
    v_lshl_add_u32 v18, v1, 4, s52
    s_lshl_b32 s52, s53, 4
    v_add_u32 v19, s52, v200
    v_mul_u32_u24 v19, 80, v19
    v_add_u32 v19, 135168, v19
    s_waitcnt vmcnt(24)
    v_lshlrev_b32 v20, 16, v220
    v_and_b32 v21, 0xffff0000, v220
    v_lshlrev_b32 v28, 16, v224
    v_and_b32 v29, 0xffff0000, v224
    v_lshlrev_b32 v22, 16, v221
    v_and_b32 v23, 0xffff0000, v221
    v_lshlrev_b32 v30, 16, v225
    v_and_b32 v31, 0xffff0000, v225
    v_lshlrev_b32 v24, 16, v222
    v_and_b32 v25, 0xffff0000, v222
    v_lshlrev_b32 v32, 16, v226
    v_and_b32 v33, 0xffff0000, v226
    v_lshlrev_b32 v26, 16, v223
    v_and_b32 v27, 0xffff0000, v223
    v_lshlrev_b32 v34, 16, v227
    v_and_b32 v35, 0xffff0000, v227
    v_lshlrev_b32 v36, 16, v228
    v_lshlrev_b32 v37, 16, v229
    v_mul_f32_e64 v28, -v28, v20
    v_mul_f32_e64 v29, -v29, v21
    v_mul_f32_e64 v30, -v30, v22
    v_mul_f32_e64 v31, -v31, v23
    v_mul_f32_e64 v32, -v32, v24
    v_mul_f32_e64 v33, -v33, v25
    v_mul_f32_e64 v34, -v34, v26
    v_mul_f32_e64 v35, -v35, v27
    v_mul_f32_e64 v37, -v37, v36
    v_mul_f32 v20, 0x4b800000, v20
    v_mul_f32 v21, 0x4b800000, v21
    v_mul_f32 v22, 0x4b800000, v22
    v_mul_f32 v23, 0x4b800000, v23
    v_mul_f32 v24, 0x4b800000, v24
    v_mul_f32 v25, 0x4b800000, v25
    v_mul_f32 v26, 0x4b800000, v26
    v_mul_f32 v27, 0x4b800000, v27
    v_mul_f32 v36, 0x4b800000, v36
    s_waitcnt vmcnt(12)
    v_fma_mix_f32 v76, v76, v20, v28 op_sel_hi:[1,0,0]
    v_fma_mix_f32 v84, v84, v20, v28 op_sel_hi:[1,0,0]
    v_fma_mix_f32 v92, v92, v20, v28 op_sel_hi:[1,0,0]
    v_fma_mix_f32 v100, v100, v20, v28 op_sel_hi:[1,0,0]
    v_cvt_pk_bf16_f32 v56, v76, v84
    v_cvt_pk_bf16_f32 v57, v92, v100
    ds_write_b64 v18, v[56:57] offset:0
    v_fma_mix_f32 v77, v77, v21, v29 op_sel_hi:[1,0,0]
    v_fma_mix_f32 v85, v85, v21, v29 op_sel_hi:[1,0,0]
    v_fma_mix_f32 v93, v93, v21, v29 op_sel_hi:[1,0,0]
    v_fma_mix_f32 v101, v101, v21, v29 op_sel_hi:[1,0,0]
    v_cvt_pk_bf16_f32 v58, v77, v85
    v_cvt_pk_bf16_f32 v59, v93, v101
    ds_write_b64 v18, v[58:59] offset:1024
    v_fma_mix_f32 v78, v78, v22, v30 op_sel_hi:[1,0,0]
    v_fma_mix_f32 v86, v86, v22, v30 op_sel_hi:[1,0,0]
    v_fma_mix_f32 v94, v94, v22, v30 op_sel_hi:[1,0,0]
    v_fma_mix_f32 v102, v102, v22, v30 op_sel_hi:[1,0,0]
    v_cvt_pk_bf16_f32 v60, v78, v86
    v_cvt_pk_bf16_f32 v61, v94, v102
    ds_write_b64 v18, v[60:61] offset:2048
    v_fma_mix_f32 v79, v79, v23, v31 op_sel_hi:[1,0,0]
    v_fma_mix_f32 v87, v87, v23, v31 op_sel_hi:[1,0,0]
    v_fma_mix_f32 v95, v95, v23, v31 op_sel_hi:[1,0,0]
    v_fma_mix_f32 v103, v103, v23, v31 op_sel_hi:[1,0,0]
    v_cvt_pk_bf16_f32 v62, v79, v87
    v_cvt_pk_bf16_f32 v63, v95, v103
    ds_write_b64 v18, v[62:63] offset:3072
    v_fma_mix_f32 v80, v80, v24, v32 op_sel_hi:[1,0,0]
    v_fma_mix_f32 v88, v88, v24, v32 op_sel_hi:[1,0,0]
    v_fma_mix_f32 v96, v96, v24, v32 op_sel_hi:[1,0,0]
    v_fma_mix_f32 v104, v104, v24, v32 op_sel_hi:[1,0,0]
    v_cvt_pk_bf16_f32 v64, v80, v88
    v_cvt_pk_bf16_f32 v65, v96, v104
    ds_write_b64 v18, v[64:65] offset:4096
    v_fma_mix_f32 v81, v81, v25, v33 op_sel_hi:[1,0,0]
    v_fma_mix_f32 v89, v89, v25, v33 op_sel_hi:[1,0,0]
    v_fma_mix_f32 v97, v97, v25, v33 op_sel_hi:[1,0,0]
    v_fma_mix_f32 v105, v105, v25, v33 op_sel_hi:[1,0,0]
    v_cvt_pk_bf16_f32 v66, v81, v89
    v_cvt_pk_bf16_f32 v67, v97, v105
    ds_write_b64 v18, v[66:67] offset:5120
    v_fma_mix_f32 v82, v82, v26, v34 op_sel_hi:[1,0,0]
    v_fma_mix_f32 v90, v90, v26, v34 op_sel_hi:[1,0,0]
    v_fma_mix_f32 v98, v98, v26, v34 op_sel_hi:[1,0,0]
    v_fma_mix_f32 v106, v106, v26, v34 op_sel_hi:[1,0,0]
    v_cvt_pk_bf16_f32 v68, v82, v90
    v_cvt_pk_bf16_f32 v69, v98, v106
    ds_write_b64 v18, v[68:69] offset:6144
    v_fma_mix_f32 v83, v83, v27, v35 op_sel_hi:[1,0,0]
    v_fma_mix_f32 v91, v91, v27, v35 op_sel_hi:[1,0,0]
    v_fma_mix_f32 v99, v99, v27, v35 op_sel_hi:[1,0,0]
    v_fma_mix_f32 v107, v107, v27, v35 op_sel_hi:[1,0,0]
    v_cvt_pk_bf16_f32 v70, v83, v91
    v_cvt_pk_bf16_f32 v71, v99, v107
    ds_write_b64 v18, v[70:71] offset:7168
    v_fma_mix_f32 v108, v108, v36, v37 op_sel_hi:[1,0,0]
    v_fma_mix_f32 v109, v109, v36, v37 op_sel_hi:[1,0,0]
    v_fma_mix_f32 v110, v110, v36, v37 op_sel_hi:[1,0,0]
    v_fma_mix_f32 v111, v111, v36, v37 op_sel_hi:[1,0,0]
    v_cvt_pk_bf16_f32 v72, v108, v109
    v_cvt_pk_bf16_f32 v73, v110, v111
    ds_write_b64 v18, v[72:73] offset:8192
    buffer_load_dwordx4 v[148:151], v2, s[20:23], s54 offen
    buffer_load_dwordx4 v[152:155], v2, s[20:23], s54 offen offset:16
    buffer_load_dword v180, v6, s[20:23], s54 offen
    buffer_load_dwordx4 v[156:159], v3, s[20:23], s54 offen
    buffer_load_dwordx4 v[160:163], v3, s[20:23], s54 offen offset:16
    buffer_load_dword v181, v7, s[20:23], s54 offen
    buffer_load_dwordx4 v[164:167], v4, s[20:23], s54 offen
    buffer_load_dwordx4 v[168:171], v4, s[20:23], s54 offen offset:16
    buffer_load_dword v182, v8, s[20:23], s54 offen
    buffer_load_dwordx4 v[172:175], v5, s[20:23], s54 offen
    buffer_load_dwordx4 v[176:179], v5, s[20:23], s54 offen offset:16
    buffer_load_dword v183, v9, s[20:23], s54 offen
    s_add_u32 s54, s54, 1179648
    s_cmp_ge_u32 s54, 10616832
    s_cselect_b32 s54, 0, s54
    s_waitcnt lgkmcnt(0)
    s_barrier
    ds_read_b128 v[38:41], v19 offset:2560
    ds_read_b128 v[42:45], v19 offset:2576
    ds_read_b128 v[46:49], v19 offset:2592
    ds_read_b128 v[50:53], v19 offset:2608
    ds_read_b64 v[54:55], v19 offset:2624
    buffer_load_dwordx4 v[76:79], v2, s[20:23], s54 offen
    buffer_load_dwordx4 v[80:83], v2, s[20:23], s54 offen offset:16
    s_waitcnt vmcnt(14)
    s_waitcnt lgkmcnt(0)
    v_fma_mix_f32 v112, v112, v38, v46 op_sel_hi:[1,0,0]
    v_fma_mix_f32 v120, v120, v38, v46 op_sel_hi:[1,0,0]
    v_fma_mix_f32 v128, v128, v38, v46 op_sel_hi:[1,0,0]
    v_fma_mix_f32 v136, v136, v38, v46 op_sel_hi:[1,0,0]
    buffer_load_dword v108, v6, s[20:23], s54 offen
    v_cvt_pk_bf16_f32 v56, v112, v120
    v_cvt_pk_bf16_f32 v57, v128, v136
    ds_write_b64 v18, v[56:57] offset:18432
    v_fma_mix_f32 v113, v113, v39, v47 op_sel_hi:[1,0,0]
    v_fma_mix_f32 v121, v121, v39, v47 op_sel_hi:[1,0,0]
    v_fma_mix_f32 v129, v129, v39, v47 op_sel_hi:[1,0,0]
    v_fma_mix_f32 v137, v137, v39, v47 op_sel_hi:[1,0,0]
    v_cvt_pk_bf16_f32 v58, v113, v121
    buffer_load_dwordx4 v[84:87], v3, s[20:23], s54 offen
    v_cvt_pk_bf16_f32 v59, v129, v137
    ds_write_b64 v18, v[58:59] offset:19456
    v_fma_mix_f32 v114, v114, v40, v48 op_sel_hi:[1,0,0]
    v_fma_mix_f32 v122, v122, v40, v48 op_sel_hi:[1,0,0]
    v_fma_mix_f32 v130, v130, v40, v48 op_sel_hi:[1,0,0]
    v_fma_mix_f32 v138, v138, v40, v48 op_sel_hi:[1,0,0]
    v_cvt_pk_bf16_f32 v60, v114, v122
    v_cvt_pk_bf16_f32 v61, v130, v138
    ds_write_b64 v18, v[60:61] offset:20480
    buffer_load_dwordx4 v[88:91], v3, s[20:23], s54 offen offset:16
    v_fma_mix_f32 v115, v115, v41, v49 op_sel_hi:[1,0,0]
    v_fma_mix_f32 v123, v123, v41, v49 op_sel_hi:[1,0,0]
    v_fma_mix_f32 v131, v131, v41, v49 op_sel_hi:[1,0,0]
    v_fma_mix_f32 v139, v139, v41, v49 op_sel_hi:[1,0,0]
    v_cvt_pk_bf16_f32 v62, v115, v123
    v_cvt_pk_bf16_f32 v63, v131, v139
    ds_write_b64 v18, v[62:63] offset:21504
    v_fma_mix_f32 v116, v116, v42, v50 op_sel_hi:[1,0,0]
    buffer_load_dword v109, v7, s[20:23], s54 offen
    v_fma_mix_f32 v124, v124, v42, v50 op_sel_hi:[1,0,0]
    v_fma_mix_f32 v132, v132, v42, v50 op_sel_hi:[1,0,0]
    v_fma_mix_f32 v140, v140, v42, v50 op_sel_hi:[1,0,0]
    v_cvt_pk_bf16_f32 v64, v116, v124
    v_cvt_pk_bf16_f32 v65, v132, v140
    ds_write_b64 v18, v[64:65] offset:22528
    ds_read_b128 v[20:23], v19 offset:5120
    ds_read_b128 v[24:27], v19 offset:5136
    ds_read_b128 v[28:31], v19 offset:5152
    buffer_load_dwordx4 v[92:95], v4, s[20:23], s54 offen
    ds_read_b128 v[32:35], v19 offset:5168
    ds_read_b64 v[36:37], v19 offset:5184
    v_fma_mix_f32 v117, v117, v43, v51 op_sel_hi:[1,0,0]
    v_fma_mix_f32 v125, v125, v43, v51 op_sel_hi:[1,0,0]
    v_fma_mix_f32 v133, v133, v43, v51 op_sel_hi:[1,0,0]
    v_fma_mix_f32 v141, v141, v43, v51 op_sel_hi:[1,0,0]
    v_cvt_pk_bf16_f32 v66, v117, v125
    v_cvt_pk_bf16_f32 v67, v133, v141
    buffer_load_dwordx4 v[96:99], v4, s[20:23], s54 offen offset:16
    ds_write_b64 v18, v[66:67] offset:23552
    v_fma_mix_f32 v118, v118, v44, v52 op_sel_hi:[1,0,0]
    v_fma_mix_f32 v126, v126, v44, v52 op_sel_hi:[1,0,0]
    v_fma_mix_f32 v134, v134, v44, v52 op_sel_hi:[1,0,0]
    v_fma_mix_f32 v142, v142, v44, v52 op_sel_hi:[1,0,0]
    v_cvt_pk_bf16_f32 v68, v118, v126
    v_cvt_pk_bf16_f32 v69, v134, v142
    ds_write_b64 v18, v[68:69] offset:24576
    v_fma_mix_f32 v119, v119, v45, v53 op_sel_hi:[1,0,0]
    buffer_load_dword v110, v8, s[20:23], s54 offen
    v_fma_mix_f32 v127, v127, v45, v53 op_sel_hi:[1,0,0]
    v_fma_mix_f32 v135, v135, v45, v53 op_sel_hi:[1,0,0]
    v_fma_mix_f32 v143, v143, v45, v53 op_sel_hi:[1,0,0]
    v_cvt_pk_bf16_f32 v70, v119, v127
    v_cvt_pk_bf16_f32 v71, v135, v143
    ds_write_b64 v18, v[70:71] offset:25600
    v_fma_mix_f32 v144, v144, v54, v55 op_sel_hi:[1,0,0]
    v_fma_mix_f32 v145, v145, v54, v55 op_sel_hi:[1,0,0]
    buffer_load_dwordx4 v[100:103], v5, s[20:23], s54 offen
    v_fma_mix_f32 v146, v146, v54, v55 op_sel_hi:[1,0,0]
    v_fma_mix_f32 v147, v147, v54, v55 op_sel_hi:[1,0,0]
    v_cvt_pk_bf16_f32 v72, v144, v145
    v_cvt_pk_bf16_f32 v73, v146, v147
    ds_write_b64 v18, v[72:73] offset:26624
    buffer_load_dwordx4 v[104:107], v5, s[20:23], s54 offen offset:16
    buffer_load_dword v111, v9, s[20:23], s54 offen
    s_add_u32 s54, s54, 1179648
    s_cmp_ge_u32 s54, 10616832
    s_cselect_b32 s54, 0, s54
    s_waitcnt lgkmcnt(0)
    s_barrier
    buffer_load_dwordx4 v[112:115], v2, s[20:23], s54 offen
    buffer_load_dwordx4 v[116:119], v2, s[20:23], s54 offen offset:16
    s_waitcnt vmcnt(14)
    v_fma_mix_f32 v148, v148, v20, v28 op_sel_hi:[1,0,0]
    v_fma_mix_f32 v156, v156, v20, v28 op_sel_hi:[1,0,0]
    v_fma_mix_f32 v164, v164, v20, v28 op_sel_hi:[1,0,0]
    v_fma_mix_f32 v172, v172, v20, v28 op_sel_hi:[1,0,0]
    buffer_load_dword v144, v6, s[20:23], s54 offen
    v_cvt_pk_bf16_f32 v56, v148, v156
    v_cvt_pk_bf16_f32 v57, v164, v172
    ds_write_b64 v18, v[56:57] offset:0
    v_fma_mix_f32 v149, v149, v21, v29 op_sel_hi:[1,0,0]
    v_fma_mix_f32 v157, v157, v21, v29 op_sel_hi:[1,0,0]
    v_fma_mix_f32 v165, v165, v21, v29 op_sel_hi:[1,0,0]
    v_fma_mix_f32 v173, v173, v21, v29 op_sel_hi:[1,0,0]
    v_cvt_pk_bf16_f32 v58, v149, v157
    buffer_load_dwordx4 v[120:123], v3, s[20:23], s54 offen
    v_cvt_pk_bf16_f32 v59, v165, v173
    ds_write_b64 v18, v[58:59] offset:1024
    v_fma_mix_f32 v150, v150, v22, v30 op_sel_hi:[1,0,0]
    v_fma_mix_f32 v158, v158, v22, v30 op_sel_hi:[1,0,0]
    v_fma_mix_f32 v166, v166, v22, v30 op_sel_hi:[1,0,0]
    v_fma_mix_f32 v174, v174, v22, v30 op_sel_hi:[1,0,0]
    v_cvt_pk_bf16_f32 v60, v150, v158
    v_cvt_pk_bf16_f32 v61, v166, v174
    ds_write_b64 v18, v[60:61] offset:2048
    buffer_load_dwordx4 v[124:127], v3, s[20:23], s54 offen offset:16
    v_fma_mix_f32 v151, v151, v23, v31 op_sel_hi:[1,0,0]
    v_fma_mix_f32 v159, v159, v23, v31 op_sel_hi:[1,0,0]
    v_fma_mix_f32 v167, v167, v23, v31 op_sel_hi:[1,0,0]
    v_fma_mix_f32 v175, v175, v23, v31 op_sel_hi:[1,0,0]
    v_cvt_pk_bf16_f32 v62, v151, v159
    v_cvt_pk_bf16_f32 v63, v167, v175
    ds_write_b64 v18, v[62:63] offset:3072
    v_fma_mix_f32 v152, v152, v24, v32 op_sel_hi:[1,0,0]
    buffer_load_dword v145, v7, s[20:23], s54 offen
    v_fma_mix_f32 v160, v160, v24, v32 op_sel_hi:[1,0,0]
    v_fma_mix_f32 v168, v168, v24, v32 op_sel_hi:[1,0,0]
    v_fma_mix_f32 v176, v176, v24, v32 op_sel_hi:[1,0,0]
    v_cvt_pk_bf16_f32 v64, v152, v160
    v_cvt_pk_bf16_f32 v65, v168, v176
    ds_write_b64 v18, v[64:65] offset:4096
    ds_read_b128 v[38:41], v19 offset:7680
    ds_read_b128 v[42:45], v19 offset:7696
    ds_read_b128 v[46:49], v19 offset:7712
    buffer_load_dwordx4 v[128:131], v4, s[20:23], s54 offen
    ds_read_b128 v[50:53], v19 offset:7728
    ds_read_b64 v[54:55], v19 offset:7744
    v_fma_mix_f32 v153, v153, v25, v33 op_sel_hi:[1,0,0]
    v_fma_mix_f32 v161, v161, v25, v33 op_sel_hi:[1,0,0]
    v_fma_mix_f32 v169, v169, v25, v33 op_sel_hi:[1,0,0]
    v_fma_mix_f32 v177, v177, v25, v33 op_sel_hi:[1,0,0]
    v_cvt_pk_bf16_f32 v66, v153, v161
    v_cvt_pk_bf16_f32 v67, v169, v177
    buffer_load_dwordx4 v[132:135], v4, s[20:23], s54 offen offset:16
    ds_write_b64 v18, v[66:67] offset:5120
    v_fma_mix_f32 v154, v154, v26, v34 op_sel_hi:[1,0,0]
    v_fma_mix_f32 v162, v162, v26, v34 op_sel_hi:[1,0,0]
    v_fma_mix_f32 v170, v170, v26, v34 op_sel_hi:[1,0,0]
    v_fma_mix_f32 v178, v178, v26, v34 op_sel_hi:[1,0,0]
    v_cvt_pk_bf16_f32 v68, v154, v162
    v_cvt_pk_bf16_f32 v69, v170, v178
    ds_write_b64 v18, v[68:69] offset:6144
    v_fma_mix_f32 v155, v155, v27, v35 op_sel_hi:[1,0,0]
    buffer_load_dword v146, v8, s[20:23], s54 offen
    v_fma_mix_f32 v163, v163, v27, v35 op_sel_hi:[1,0,0]
    v_fma_mix_f32 v171, v171, v27, v35 op_sel_hi:[1,0,0]
    v_fma_mix_f32 v179, v179, v27, v35 op_sel_hi:[1,0,0]
    v_cvt_pk_bf16_f32 v70, v155, v163
    v_cvt_pk_bf16_f32 v71, v171, v179
    ds_write_b64 v18, v[70:71] offset:7168
    v_fma_mix_f32 v180, v180, v36, v37 op_sel_hi:[1,0,0]
    v_fma_mix_f32 v181, v181, v36, v37 op_sel_hi:[1,0,0]
    buffer_load_dwordx4 v[136:139], v5, s[20:23], s54 offen
    v_fma_mix_f32 v182, v182, v36, v37 op_sel_hi:[1,0,0]
    v_fma_mix_f32 v183, v183, v36, v37 op_sel_hi:[1,0,0]
    v_cvt_pk_bf16_f32 v72, v180, v181
    v_cvt_pk_bf16_f32 v73, v182, v183
    ds_write_b64 v18, v[72:73] offset:8192
    buffer_load_dwordx4 v[140:143], v5, s[20:23], s54 offen offset:16
    buffer_load_dword v147, v9, s[20:23], s54 offen
    s_add_u32 s54, s54, 1179648
    s_cmp_ge_u32 s54, 10616832
    s_cselect_b32 s54, 0, s54
    s_waitcnt lgkmcnt(0)
    s_barrier
    buffer_load_dwordx4 v[148:151], v2, s[20:23], s54 offen
    buffer_load_dwordx4 v[152:155], v2, s[20:23], s54 offen offset:16
    s_waitcnt vmcnt(14)
    v_fma_mix_f32 v76, v76, v38, v46 op_sel_hi:[1,0,0]
    v_fma_mix_f32 v84, v84, v38, v46 op_sel_hi:[1,0,0]
    v_fma_mix_f32 v92, v92, v38, v46 op_sel_hi:[1,0,0]
    v_fma_mix_f32 v100, v100, v38, v46 op_sel_hi:[1,0,0]
    buffer_load_dword v180, v6, s[20:23], s54 offen
    v_cvt_pk_bf16_f32 v56, v76, v84
    v_cvt_pk_bf16_f32 v57, v92, v100
    ds_write_b64 v18, v[56:57] offset:18432
    v_fma_mix_f32 v77, v77, v39, v47 op_sel_hi:[1,0,0]
    v_fma_mix_f32 v85, v85, v39, v47 op_sel_hi:[1,0,0]
    v_fma_mix_f32 v93, v93, v39, v47 op_sel_hi:[1,0,0]
    v_fma_mix_f32 v101, v101, v39, v47 op_sel_hi:[1,0,0]
    v_cvt_pk_bf16_f32 v58, v77, v85
    buffer_load_dwordx4 v[156:159], v3, s[20:23], s54 offen
    v_cvt_pk_bf16_f32 v59, v93, v101
    ds_write_b64 v18, v[58:59] offset:19456
    v_fma_mix_f32 v78, v78, v40, v48 op_sel_hi:[1,0,0]
    v_fma_mix_f32 v86, v86, v40, v48 op_sel_hi:[1,0,0]
    v_fma_mix_f32 v94, v94, v40, v48 op_sel_hi:[1,0,0]
    v_fma_mix_f32 v102, v102, v40, v48 op_sel_hi:[1,0,0]
    v_cvt_pk_bf16_f32 v60, v78, v86
    v_cvt_pk_bf16_f32 v61, v94, v102
    ds_write_b64 v18, v[60:61] offset:20480
    buffer_load_dwordx4 v[160:163], v3, s[20:23], s54 offen offset:16
    v_fma_mix_f32 v79, v79, v41, v49 op_sel_hi:[1,0,0]
    v_fma_mix_f32 v87, v87, v41, v49 op_sel_hi:[1,0,0]
    v_fma_mix_f32 v95, v95, v41, v49 op_sel_hi:[1,0,0]
    v_fma_mix_f32 v103, v103, v41, v49 op_sel_hi:[1,0,0]
    v_cvt_pk_bf16_f32 v62, v79, v87
    v_cvt_pk_bf16_f32 v63, v95, v103
    ds_write_b64 v18, v[62:63] offset:21504
    v_fma_mix_f32 v80, v80, v42, v50 op_sel_hi:[1,0,0]
    buffer_load_dword v181, v7, s[20:23], s54 offen
    v_fma_mix_f32 v88, v88, v42, v50 op_sel_hi:[1,0,0]
    v_fma_mix_f32 v96, v96, v42, v50 op_sel_hi:[1,0,0]
    v_fma_mix_f32 v104, v104, v42, v50 op_sel_hi:[1,0,0]
    v_cvt_pk_bf16_f32 v64, v80, v88
    v_cvt_pk_bf16_f32 v65, v96, v104
    ds_write_b64 v18, v[64:65] offset:22528
    ds_read_b128 v[20:23], v19 offset:10240
    ds_read_b128 v[24:27], v19 offset:10256
    ds_read_b128 v[28:31], v19 offset:10272
    buffer_load_dwordx4 v[164:167], v4, s[20:23], s54 offen
    ds_read_b128 v[32:35], v19 offset:10288
    ds_read_b64 v[36:37], v19 offset:10304
    v_fma_mix_f32 v81, v81, v43, v51 op_sel_hi:[1,0,0]
    v_fma_mix_f32 v89, v89, v43, v51 op_sel_hi:[1,0,0]
    v_fma_mix_f32 v97, v97, v43, v51 op_sel_hi:[1,0,0]
    v_fma_mix_f32 v105, v105, v43, v51 op_sel_hi:[1,0,0]
    v_cvt_pk_bf16_f32 v66, v81, v89
    v_cvt_pk_bf16_f32 v67, v97, v105
    buffer_load_dwordx4 v[168:171], v4, s[20:23], s54 offen offset:16
    ds_write_b64 v18, v[66:67] offset:23552
    v_fma_mix_f32 v82, v82, v44, v52 op_sel_hi:[1,0,0]
    v_fma_mix_f32 v90, v90, v44, v52 op_sel_hi:[1,0,0]
    v_fma_mix_f32 v98, v98, v44, v52 op_sel_hi:[1,0,0]
    v_fma_mix_f32 v106, v106, v44, v52 op_sel_hi:[1,0,0]
    v_cvt_pk_bf16_f32 v68, v82, v90
    v_cvt_pk_bf16_f32 v69, v98, v106
    ds_write_b64 v18, v[68:69] offset:24576
    v_fma_mix_f32 v83, v83, v45, v53 op_sel_hi:[1,0,0]
    buffer_load_dword v182, v8, s[20:23], s54 offen
    v_fma_mix_f32 v91, v91, v45, v53 op_sel_hi:[1,0,0]
    v_fma_mix_f32 v99, v99, v45, v53 op_sel_hi:[1,0,0]
    v_fma_mix_f32 v107, v107, v45, v53 op_sel_hi:[1,0,0]
    v_cvt_pk_bf16_f32 v70, v83, v91
    v_cvt_pk_bf16_f32 v71, v99, v107
    ds_write_b64 v18, v[70:71] offset:25600
    v_fma_mix_f32 v108, v108, v54, v55 op_sel_hi:[1,0,0]
    v_fma_mix_f32 v109, v109, v54, v55 op_sel_hi:[1,0,0]
    buffer_load_dwordx4 v[172:175], v5, s[20:23], s54 offen
    v_fma_mix_f32 v110, v110, v54, v55 op_sel_hi:[1,0,0]
    v_fma_mix_f32 v111, v111, v54, v55 op_sel_hi:[1,0,0]
    v_cvt_pk_bf16_f32 v72, v108, v109
    v_cvt_pk_bf16_f32 v73, v110, v111
    ds_write_b64 v18, v[72:73] offset:26624
    buffer_load_dwordx4 v[176:179], v5, s[20:23], s54 offen offset:16
    buffer_load_dword v183, v9, s[20:23], s54 offen
    s_add_u32 s54, s54, 1179648
    s_cmp_ge_u32 s54, 10616832
    s_cselect_b32 s54, 0, s54
    s_waitcnt lgkmcnt(0)
    s_barrier
    buffer_load_dwordx4 v[76:79], v2, s[20:23], s54 offen
    buffer_load_dwordx4 v[80:83], v2, s[20:23], s54 offen offset:16
    s_waitcnt vmcnt(14)
    v_fma_mix_f32 v112, v112, v20, v28 op_sel_hi:[1,0,0]
    v_fma_mix_f32 v120, v120, v20, v28 op_sel_hi:[1,0,0]
    v_fma_mix_f32 v128, v128, v20, v28 op_sel_hi:[1,0,0]
    v_fma_mix_f32 v136, v136, v20, v28 op_sel_hi:[1,0,0]
    buffer_load_dword v108, v6, s[20:23], s54 offen
    v_cvt_pk_bf16_f32 v56, v112, v120
    v_cvt_pk_bf16_f32 v57, v128, v136
    ds_write_b64 v18, v[56:57] offset:0
    v_fma_mix_f32 v113, v113, v21, v29 op_sel_hi:[1,0,0]
    v_fma_mix_f32 v121, v121, v21, v29 op_sel_hi:[1,0,0]
    v_fma_mix_f32 v129, v129, v21, v29 op_sel_hi:[1,0,0]
    v_fma_mix_f32 v137, v137, v21, v29 op_sel_hi:[1,0,0]
    v_cvt_pk_bf16_f32 v58, v113, v121
    buffer_load_dwordx4 v[84:87], v3, s[20:23], s54 offen
    v_cvt_pk_bf16_f32 v59, v129, v137
    ds_write_b64 v18, v[58:59] offset:1024
    v_fma_mix_f32 v114, v114, v22, v30 op_sel_hi:[1,0,0]
    v_fma_mix_f32 v122, v122, v22, v30 op_sel_hi:[1,0,0]
    v_fma_mix_f32 v130, v130, v22, v30 op_sel_hi:[1,0,0]
    v_fma_mix_f32 v138, v138, v22, v30 op_sel_hi:[1,0,0]
    v_cvt_pk_bf16_f32 v60, v114, v122
    v_cvt_pk_bf16_f32 v61, v130, v138
    ds_write_b64 v18, v[60:61] offset:2048
    buffer_load_dwordx4 v[88:91], v3, s[20:23], s54 offen offset:16
    v_fma_mix_f32 v115, v115, v23, v31 op_sel_hi:[1,0,0]
    v_fma_mix_f32 v123, v123, v23, v31 op_sel_hi:[1,0,0]
    v_fma_mix_f32 v131, v131, v23, v31 op_sel_hi:[1,0,0]
    v_fma_mix_f32 v139, v139, v23, v31 op_sel_hi:[1,0,0]
    v_cvt_pk_bf16_f32 v62, v115, v123
    v_cvt_pk_bf16_f32 v63, v131, v139
    ds_write_b64 v18, v[62:63] offset:3072
    v_fma_mix_f32 v116, v116, v24, v32 op_sel_hi:[1,0,0]
    buffer_load_dword v109, v7, s[20:23], s54 offen
    v_fma_mix_f32 v124, v124, v24, v32 op_sel_hi:[1,0,0]
    v_fma_mix_f32 v132, v132, v24, v32 op_sel_hi:[1,0,0]
    v_fma_mix_f32 v140, v140, v24, v32 op_sel_hi:[1,0,0]
    v_cvt_pk_bf16_f32 v64, v116, v124
    v_cvt_pk_bf16_f32 v65, v132, v140
    ds_write_b64 v18, v[64:65] offset:4096
    ds_read_b128 v[38:41], v19 offset:12800
    ds_read_b128 v[42:45], v19 offset:12816
    ds_read_b128 v[46:49], v19 offset:12832
    buffer_load_dwordx4 v[92:95], v4, s[20:23], s54 offen
    ds_read_b128 v[50:53], v19 offset:12848
    ds_read_b64 v[54:55], v19 offset:12864
    v_fma_mix_f32 v117, v117, v25, v33 op_sel_hi:[1,0,0]
    v_fma_mix_f32 v125, v125, v25, v33 op_sel_hi:[1,0,0]
    v_fma_mix_f32 v133, v133, v25, v33 op_sel_hi:[1,0,0]
    v_fma_mix_f32 v141, v141, v25, v33 op_sel_hi:[1,0,0]
    v_cvt_pk_bf16_f32 v66, v117, v125
    v_cvt_pk_bf16_f32 v67, v133, v141
    buffer_load_dwordx4 v[96:99], v4, s[20:23], s54 offen offset:16
    ds_write_b64 v18, v[66:67] offset:5120
    v_fma_mix_f32 v118, v118, v26, v34 op_sel_hi:[1,0,0]
    v_fma_mix_f32 v126, v126, v26, v34 op_sel_hi:[1,0,0]
    v_fma_mix_f32 v134, v134, v26, v34 op_sel_hi:[1,0,0]
    v_fma_mix_f32 v142, v142, v26, v34 op_sel_hi:[1,0,0]
    v_cvt_pk_bf16_f32 v68, v118, v126
    v_cvt_pk_bf16_f32 v69, v134, v142
    ds_write_b64 v18, v[68:69] offset:6144
    v_fma_mix_f32 v119, v119, v27, v35 op_sel_hi:[1,0,0]
    buffer_load_dword v110, v8, s[20:23], s54 offen
    v_fma_mix_f32 v127, v127, v27, v35 op_sel_hi:[1,0,0]
    v_fma_mix_f32 v135, v135, v27, v35 op_sel_hi:[1,0,0]
    v_fma_mix_f32 v143, v143, v27, v35 op_sel_hi:[1,0,0]
    v_cvt_pk_bf16_f32 v70, v119, v127
    v_cvt_pk_bf16_f32 v71, v135, v143
    ds_write_b64 v18, v[70:71] offset:7168
    v_fma_mix_f32 v144, v144, v36, v37 op_sel_hi:[1,0,0]
    v_fma_mix_f32 v145, v145, v36, v37 op_sel_hi:[1,0,0]
    buffer_load_dwordx4 v[100:103], v5, s[20:23], s54 offen
    v_fma_mix_f32 v146, v146, v36, v37 op_sel_hi:[1,0,0]
    v_fma_mix_f32 v147, v147, v36, v37 op_sel_hi:[1,0,0]
    v_cvt_pk_bf16_f32 v72, v144, v145
    v_cvt_pk_bf16_f32 v73, v146, v147
    ds_write_b64 v18, v[72:73] offset:8192
    buffer_load_dwordx4 v[104:107], v5, s[20:23], s54 offen offset:16
    buffer_load_dword v111, v9, s[20:23], s54 offen
    s_add_u32 s54, s54, 1179648
    s_cmp_ge_u32 s54, 10616832
    s_cselect_b32 s54, 0, s54
    s_waitcnt lgkmcnt(0)
    s_barrier
    buffer_load_dwordx4 v[112:115], v2, s[20:23], s54 offen
    buffer_load_dwordx4 v[116:119], v2, s[20:23], s54 offen offset:16
    s_waitcnt vmcnt(14)
    v_fma_mix_f32 v148, v148, v38, v46 op_sel_hi:[1,0,0]
    v_fma_mix_f32 v156, v156, v38, v46 op_sel_hi:[1,0,0]
    v_fma_mix_f32 v164, v164, v38, v46 op_sel_hi:[1,0,0]
    v_fma_mix_f32 v172, v172, v38, v46 op_sel_hi:[1,0,0]
    buffer_load_dword v144, v6, s[20:23], s54 offen
    v_cvt_pk_bf16_f32 v56, v148, v156
    v_cvt_pk_bf16_f32 v57, v164, v172
    ds_write_b64 v18, v[56:57] offset:18432
    v_fma_mix_f32 v149, v149, v39, v47 op_sel_hi:[1,0,0]
    v_fma_mix_f32 v157, v157, v39, v47 op_sel_hi:[1,0,0]
    v_fma_mix_f32 v165, v165, v39, v47 op_sel_hi:[1,0,0]
    v_fma_mix_f32 v173, v173, v39, v47 op_sel_hi:[1,0,0]
    v_cvt_pk_bf16_f32 v58, v149, v157
    buffer_load_dwordx4 v[120:123], v3, s[20:23], s54 offen
    v_cvt_pk_bf16_f32 v59, v165, v173
    ds_write_b64 v18, v[58:59] offset:19456
    v_fma_mix_f32 v150, v150, v40, v48 op_sel_hi:[1,0,0]
    v_fma_mix_f32 v158, v158, v40, v48 op_sel_hi:[1,0,0]
    v_fma_mix_f32 v166, v166, v40, v48 op_sel_hi:[1,0,0]
    v_fma_mix_f32 v174, v174, v40, v48 op_sel_hi:[1,0,0]
    v_cvt_pk_bf16_f32 v60, v150, v158
    v_cvt_pk_bf16_f32 v61, v166, v174
    ds_write_b64 v18, v[60:61] offset:20480
    buffer_load_dwordx4 v[124:127], v3, s[20:23], s54 offen offset:16
    v_fma_mix_f32 v151, v151, v41, v49 op_sel_hi:[1,0,0]
    v_fma_mix_f32 v159, v159, v41, v49 op_sel_hi:[1,0,0]
    v_fma_mix_f32 v167, v167, v41, v49 op_sel_hi:[1,0,0]
    v_fma_mix_f32 v175, v175, v41, v49 op_sel_hi:[1,0,0]
    v_cvt_pk_bf16_f32 v62, v151, v159
    v_cvt_pk_bf16_f32 v63, v167, v175
    ds_write_b64 v18, v[62:63] offset:21504
    v_fma_mix_f32 v152, v152, v42, v50 op_sel_hi:[1,0,0]
    buffer_load_dword v145, v7, s[20:23], s54 offen
    v_fma_mix_f32 v160, v160, v42, v50 op_sel_hi:[1,0,0]
    v_fma_mix_f32 v168, v168, v42, v50 op_sel_hi:[1,0,0]
    v_fma_mix_f32 v176, v176, v42, v50 op_sel_hi:[1,0,0]
    v_cvt_pk_bf16_f32 v64, v152, v160
    v_cvt_pk_bf16_f32 v65, v168, v176
    ds_write_b64 v18, v[64:65] offset:22528
    ds_read_b128 v[20:23], v19 offset:15360
    ds_read_b128 v[24:27], v19 offset:15376
    ds_read_b128 v[28:31], v19 offset:15392
    buffer_load_dwordx4 v[128:131], v4, s[20:23], s54 offen
    ds_read_b128 v[32:35], v19 offset:15408
    ds_read_b64 v[36:37], v19 offset:15424
    v_fma_mix_f32 v153, v153, v43, v51 op_sel_hi:[1,0,0]
    v_fma_mix_f32 v161, v161, v43, v51 op_sel_hi:[1,0,0]
    v_fma_mix_f32 v169, v169, v43, v51 op_sel_hi:[1,0,0]
    v_fma_mix_f32 v177, v177, v43, v51 op_sel_hi:[1,0,0]
    v_cvt_pk_bf16_f32 v66, v153, v161
    v_cvt_pk_bf16_f32 v67, v169, v177
    buffer_load_dwordx4 v[132:135], v4, s[20:23], s54 offen offset:16
    ds_write_b64 v18, v[66:67] offset:23552
    v_fma_mix_f32 v154, v154, v44, v52 op_sel_hi:[1,0,0]
    v_fma_mix_f32 v162, v162, v44, v52 op_sel_hi:[1,0,0]
    v_fma_mix_f32 v170, v170, v44, v52 op_sel_hi:[1,0,0]
    v_fma_mix_f32 v178, v178, v44, v52 op_sel_hi:[1,0,0]
    v_cvt_pk_bf16_f32 v68, v154, v162
    v_cvt_pk_bf16_f32 v69, v170, v178
    ds_write_b64 v18, v[68:69] offset:24576
    v_fma_mix_f32 v155, v155, v45, v53 op_sel_hi:[1,0,0]
    buffer_load_dword v146, v8, s[20:23], s54 offen
    v_fma_mix_f32 v163, v163, v45, v53 op_sel_hi:[1,0,0]
    v_fma_mix_f32 v171, v171, v45, v53 op_sel_hi:[1,0,0]
    v_fma_mix_f32 v179, v179, v45, v53 op_sel_hi:[1,0,0]
    v_cvt_pk_bf16_f32 v70, v155, v163
    v_cvt_pk_bf16_f32 v71, v171, v179
    ds_write_b64 v18, v[70:71] offset:25600
    v_fma_mix_f32 v180, v180, v54, v55 op_sel_hi:[1,0,0]
    v_fma_mix_f32 v181, v181, v54, v55 op_sel_hi:[1,0,0]
    buffer_load_dwordx4 v[136:139], v5, s[20:23], s54 offen
    v_fma_mix_f32 v182, v182, v54, v55 op_sel_hi:[1,0,0]
    v_fma_mix_f32 v183, v183, v54, v55 op_sel_hi:[1,0,0]
    v_cvt_pk_bf16_f32 v72, v180, v181
    v_cvt_pk_bf16_f32 v73, v182, v183
    ds_write_b64 v18, v[72:73] offset:26624
    buffer_load_dwordx4 v[140:143], v5, s[20:23], s54 offen offset:16
    buffer_load_dword v147, v9, s[20:23], s54 offen
    s_add_u32 s54, s54, 1179648
    s_cmp_ge_u32 s54, 10616832
    s_cselect_b32 s54, 0, s54
    s_waitcnt lgkmcnt(0)
    s_barrier
    buffer_load_dwordx4 v[148:151], v2, s[20:23], s54 offen
    buffer_load_dwordx4 v[152:155], v2, s[20:23], s54 offen offset:16
    s_waitcnt vmcnt(14)
    v_fma_mix_f32 v76, v76, v20, v28 op_sel_hi:[1,0,0]
    v_fma_mix_f32 v84, v84, v20, v28 op_sel_hi:[1,0,0]
    v_fma_mix_f32 v92, v92, v20, v28 op_sel_hi:[1,0,0]
    v_fma_mix_f32 v100, v100, v20, v28 op_sel_hi:[1,0,0]
    buffer_load_dword v180, v6, s[20:23], s54 offen
    v_cvt_pk_bf16_f32 v56, v76, v84
    v_cvt_pk_bf16_f32 v57, v92, v100
    ds_write_b64 v18, v[56:57] offset:0
    v_fma_mix_f32 v77, v77, v21, v29 op_sel_hi:[1,0,0]
    v_fma_mix_f32 v85, v85, v21, v29 op_sel_hi:[1,0,0]
    v_fma_mix_f32 v93, v93, v21, v29 op_sel_hi:[1,0,0]
    v_fma_mix_f32 v101, v101, v21, v29 op_sel_hi:[1,0,0]
    v_cvt_pk_bf16_f32 v58, v77, v85
    buffer_load_dwordx4 v[156:159], v3, s[20:23], s54 offen
    v_cvt_pk_bf16_f32 v59, v93, v101
    ds_write_b64 v18, v[58:59] offset:1024
    v_fma_mix_f32 v78, v78, v22, v30 op_sel_hi:[1,0,0]
    v_fma_mix_f32 v86, v86, v22, v30 op_sel_hi:[1,0,0]
    v_fma_mix_f32 v94, v94, v22, v30 op_sel_hi:[1,0,0]
    v_fma_mix_f32 v102, v102, v22, v30 op_sel_hi:[1,0,0]
    v_cvt_pk_bf16_f32 v60, v78, v86
    v_cvt_pk_bf16_f32 v61, v94, v102
    ds_write_b64 v18, v[60:61] offset:2048
    buffer_load_dwordx4 v[160:163], v3, s[20:23], s54 offen offset:16
    v_fma_mix_f32 v79, v79, v23, v31 op_sel_hi:[1,0,0]
    v_fma_mix_f32 v87, v87, v23, v31 op_sel_hi:[1,0,0]
    v_fma_mix_f32 v95, v95, v23, v31 op_sel_hi:[1,0,0]
    v_fma_mix_f32 v103, v103, v23, v31 op_sel_hi:[1,0,0]
    v_cvt_pk_bf16_f32 v62, v79, v87
    v_cvt_pk_bf16_f32 v63, v95, v103
    ds_write_b64 v18, v[62:63] offset:3072
    v_fma_mix_f32 v80, v80, v24, v32 op_sel_hi:[1,0,0]
    buffer_load_dword v181, v7, s[20:23], s54 offen
    v_fma_mix_f32 v88, v88, v24, v32 op_sel_hi:[1,0,0]
    v_fma_mix_f32 v96, v96, v24, v32 op_sel_hi:[1,0,0]
    v_fma_mix_f32 v104, v104, v24, v32 op_sel_hi:[1,0,0]
    v_cvt_pk_bf16_f32 v64, v80, v88
    v_cvt_pk_bf16_f32 v65, v96, v104
    ds_write_b64 v18, v[64:65] offset:4096
    ds_read_b128 v[38:41], v19 offset:17920
    ds_read_b128 v[42:45], v19 offset:17936
    ds_read_b128 v[46:49], v19 offset:17952
    buffer_load_dwordx4 v[164:167], v4, s[20:23], s54 offen
    ds_read_b128 v[50:53], v19 offset:17968
    ds_read_b64 v[54:55], v19 offset:17984
    v_fma_mix_f32 v81, v81, v25, v33 op_sel_hi:[1,0,0]
    v_fma_mix_f32 v89, v89, v25, v33 op_sel_hi:[1,0,0]
    v_fma_mix_f32 v97, v97, v25, v33 op_sel_hi:[1,0,0]
    v_fma_mix_f32 v105, v105, v25, v33 op_sel_hi:[1,0,0]
    v_cvt_pk_bf16_f32 v66, v81, v89
    v_cvt_pk_bf16_f32 v67, v97, v105
    buffer_load_dwordx4 v[168:171], v4, s[20:23], s54 offen offset:16
    ds_write_b64 v18, v[66:67] offset:5120
    v_fma_mix_f32 v82, v82, v26, v34 op_sel_hi:[1,0,0]
    v_fma_mix_f32 v90, v90, v26, v34 op_sel_hi:[1,0,0]
    v_fma_mix_f32 v98, v98, v26, v34 op_sel_hi:[1,0,0]
    v_fma_mix_f32 v106, v106, v26, v34 op_sel_hi:[1,0,0]
    v_cvt_pk_bf16_f32 v68, v82, v90
    v_cvt_pk_bf16_f32 v69, v98, v106
    ds_write_b64 v18, v[68:69] offset:6144
    v_fma_mix_f32 v83, v83, v27, v35 op_sel_hi:[1,0,0]
    buffer_load_dword v182, v8, s[20:23], s54 offen
    v_fma_mix_f32 v91, v91, v27, v35 op_sel_hi:[1,0,0]
    v_fma_mix_f32 v99, v99, v27, v35 op_sel_hi:[1,0,0]
    v_fma_mix_f32 v107, v107, v27, v35 op_sel_hi:[1,0,0]
    v_cvt_pk_bf16_f32 v70, v83, v91
    v_cvt_pk_bf16_f32 v71, v99, v107
    ds_write_b64 v18, v[70:71] offset:7168
    v_fma_mix_f32 v108, v108, v36, v37 op_sel_hi:[1,0,0]
    v_fma_mix_f32 v109, v109, v36, v37 op_sel_hi:[1,0,0]
    buffer_load_dwordx4 v[172:175], v5, s[20:23], s54 offen
    v_fma_mix_f32 v110, v110, v36, v37 op_sel_hi:[1,0,0]
    v_fma_mix_f32 v111, v111, v36, v37 op_sel_hi:[1,0,0]
    v_cvt_pk_bf16_f32 v72, v108, v109
    v_cvt_pk_bf16_f32 v73, v110, v111
    ds_write_b64 v18, v[72:73] offset:8192
    buffer_load_dwordx4 v[176:179], v5, s[20:23], s54 offen offset:16
    buffer_load_dword v183, v9, s[20:23], s54 offen
    s_add_u32 s54, s54, 1179648
    s_cmp_ge_u32 s54, 10616832
    s_cselect_b32 s54, 0, s54
    s_waitcnt lgkmcnt(0)
    s_barrier
    s_waitcnt vmcnt(12)
    v_fma_mix_f32 v112, v112, v38, v46 op_sel_hi:[1,0,0]
    v_fma_mix_f32 v120, v120, v38, v46 op_sel_hi:[1,0,0]
    v_fma_mix_f32 v128, v128, v38, v46 op_sel_hi:[1,0,0]
    v_fma_mix_f32 v136, v136, v38, v46 op_sel_hi:[1,0,0]
    v_cvt_pk_bf16_f32 v56, v112, v120
    v_cvt_pk_bf16_f32 v57, v128, v136
    ds_write_b64 v18, v[56:57] offset:18432
    v_fma_mix_f32 v113, v113, v39, v47 op_sel_hi:[1,0,0]
    v_fma_mix_f32 v121, v121, v39, v47 op_sel_hi:[1,0,0]
    v_fma_mix_f32 v129, v129, v39, v47 op_sel_hi:[1,0,0]
    v_fma_mix_f32 v137, v137, v39, v47 op_sel_hi:[1,0,0]
    v_cvt_pk_bf16_f32 v58, v113, v121
    v_cvt_pk_bf16_f32 v59, v129, v137
    ds_write_b64 v18, v[58:59] offset:19456
    v_fma_mix_f32 v114, v114, v40, v48 op_sel_hi:[1,0,0]
    v_fma_mix_f32 v122, v122, v40, v48 op_sel_hi:[1,0,0]
    v_fma_mix_f32 v130, v130, v40, v48 op_sel_hi:[1,0,0]
    v_fma_mix_f32 v138, v138, v40, v48 op_sel_hi:[1,0,0]
    v_cvt_pk_bf16_f32 v60, v114, v122
    v_cvt_pk_bf16_f32 v61, v130, v138
    ds_write_b64 v18, v[60:61] offset:20480
    v_fma_mix_f32 v115, v115, v41, v49 op_sel_hi:[1,0,0]
    v_fma_mix_f32 v123, v123, v41, v49 op_sel_hi:[1,0,0]
    v_fma_mix_f32 v131, v131, v41, v49 op_sel_hi:[1,0,0]
    v_fma_mix_f32 v139, v139, v41, v49 op_sel_hi:[1,0,0]
    v_cvt_pk_bf16_f32 v62, v115, v123
    v_cvt_pk_bf16_f32 v63, v131, v139
    ds_write_b64 v18, v[62:63] offset:21504
    v_fma_mix_f32 v116, v116, v42, v50 op_sel_hi:[1,0,0]
    v_fma_mix_f32 v124, v124, v42, v50 op_sel_hi:[1,0,0]
    v_fma_mix_f32 v132, v132, v42, v50 op_sel_hi:[1,0,0]
    v_fma_mix_f32 v140, v140, v42, v50 op_sel_hi:[1,0,0]
    v_cvt_pk_bf16_f32 v64, v116, v124
    v_cvt_pk_bf16_f32 v65, v132, v140
    ds_write_b64 v18, v[64:65] offset:22528
    ds_read_b128 v[20:23], v19 offset:20480
    ds_read_b128 v[24:27], v19 offset:20496
    ds_read_b128 v[28:31], v19 offset:20512
    ds_read_b128 v[32:35], v19 offset:20528
    ds_read_b64 v[36:37], v19 offset:20544
    v_fma_mix_f32 v117, v117, v43, v51 op_sel_hi:[1,0,0]
    v_fma_mix_f32 v125, v125, v43, v51 op_sel_hi:[1,0,0]
    v_fma_mix_f32 v133, v133, v43, v51 op_sel_hi:[1,0,0]
    v_fma_mix_f32 v141, v141, v43, v51 op_sel_hi:[1,0,0]
    v_cvt_pk_bf16_f32 v66, v117, v125
    v_cvt_pk_bf16_f32 v67, v133, v141
    ds_write_b64 v18, v[66:67] offset:23552
    v_fma_mix_f32 v118, v118, v44, v52 op_sel_hi:[1,0,0]
    v_fma_mix_f32 v126, v126, v44, v52 op_sel_hi:[1,0,0]
    v_fma_mix_f32 v134, v134, v44, v52 op_sel_hi:[1,0,0]
    v_fma_mix_f32 v142, v142, v44, v52 op_sel_hi:[1,0,0]
    v_cvt_pk_bf16_f32 v68, v118, v126
    v_cvt_pk_bf16_f32 v69, v134, v142
    ds_write_b64 v18, v[68:69] offset:24576
    v_fma_mix_f32 v119, v119, v45, v53 op_sel_hi:[1,0,0]
    v_fma_mix_f32 v127, v127, v45, v53 op_sel_hi:[1,0,0]
    v_fma_mix_f32 v135, v135, v45, v53 op_sel_hi:[1,0,0]
    v_fma_mix_f32 v143, v143, v45, v53 op_sel_hi:[1,0,0]
    v_cvt_pk_bf16_f32 v70, v119, v127
    v_cvt_pk_bf16_f32 v71, v135, v143
    ds_write_b64 v18, v[70:71] offset:25600
    v_fma_mix_f32 v144, v144, v54, v55 op_sel_hi:[1,0,0]
    v_fma_mix_f32 v145, v145, v54, v55 op_sel_hi:[1,0,0]
    v_fma_mix_f32 v146, v146, v54, v55 op_sel_hi:[1,0,0]
    v_fma_mix_f32 v147, v147, v54, v55 op_sel_hi:[1,0,0]
    v_cvt_pk_bf16_f32 v72, v144, v145
    v_cvt_pk_bf16_f32 v73, v146, v147
    ds_write_b64 v18, v[72:73] offset:26624
    s_waitcnt lgkmcnt(0)
    s_barrier
    s_waitcnt vmcnt(0)
    v_fma_mix_f32 v148, v148, v20, v28 op_sel_hi:[1,0,0]
    v_fma_mix_f32 v156, v156, v20, v28 op_sel_hi:[1,0,0]
    v_fma_mix_f32 v164, v164, v20, v28 op_sel_hi:[1,0,0]
    v_fma_mix_f32 v172, v172, v20, v28 op_sel_hi:[1,0,0]
    v_cvt_pk_bf16_f32 v56, v148, v156
    v_cvt_pk_bf16_f32 v57, v164, v172
    ds_write_b64 v18, v[56:57] offset:0
    v_fma_mix_f32 v149, v149, v21, v29 op_sel_hi:[1,0,0]
    v_fma_mix_f32 v157, v157, v21, v29 op_sel_hi:[1,0,0]
    v_fma_mix_f32 v165, v165, v21, v29 op_sel_hi:[1,0,0]
    v_fma_mix_f32 v173, v173, v21, v29 op_sel_hi:[1,0,0]
    v_cvt_pk_bf16_f32 v58, v149, v157
    v_cvt_pk_bf16_f32 v59, v165, v173
    ds_write_b64 v18, v[58:59] offset:1024
    v_fma_mix_f32 v150, v150, v22, v30 op_sel_hi:[1,0,0]
    v_fma_mix_f32 v158, v158, v22, v30 op_sel_hi:[1,0,0]
    v_fma_mix_f32 v166, v166, v22, v30 op_sel_hi:[1,0,0]
    v_fma_mix_f32 v174, v174, v22, v30 op_sel_hi:[1,0,0]
    v_cvt_pk_bf16_f32 v60, v150, v158
    v_cvt_pk_bf16_f32 v61, v166, v174
    ds_write_b64 v18, v[60:61] offset:2048
    v_fma_mix_f32 v151, v151, v23, v31 op_sel_hi:[1,0,0]
    v_fma_mix_f32 v159, v159, v23, v31 op_sel_hi:[1,0,0]
    v_fma_mix_f32 v167, v167, v23, v31 op_sel_hi:[1,0,0]
    v_fma_mix_f32 v175, v175, v23, v31 op_sel_hi:[1,0,0]
    v_cvt_pk_bf16_f32 v62, v151, v159
    v_cvt_pk_bf16_f32 v63, v167, v175
    ds_write_b64 v18, v[62:63] offset:3072
    v_fma_mix_f32 v152, v152, v24, v32 op_sel_hi:[1,0,0]
    v_fma_mix_f32 v160, v160, v24, v32 op_sel_hi:[1,0,0]
    v_fma_mix_f32 v168, v168, v24, v32 op_sel_hi:[1,0,0]
    v_fma_mix_f32 v176, v176, v24, v32 op_sel_hi:[1,0,0]
    v_cvt_pk_bf16_f32 v64, v152, v160
    v_cvt_pk_bf16_f32 v65, v168, v176
    ds_write_b64 v18, v[64:65] offset:4096
    v_fma_mix_f32 v153, v153, v25, v33 op_sel_hi:[1,0,0]
    v_fma_mix_f32 v161, v161, v25, v33 op_sel_hi:[1,0,0]
    v_fma_mix_f32 v169, v169, v25, v33 op_sel_hi:[1,0,0]
    v_fma_mix_f32 v177, v177, v25, v33 op_sel_hi:[1,0,0]
    v_cvt_pk_bf16_f32 v66, v153, v161
    v_cvt_pk_bf16_f32 v67, v169, v177
    ds_write_b64 v18, v[66:67] offset:5120
    v_fma_mix_f32 v154, v154, v26, v34 op_sel_hi:[1,0,0]
    v_fma_mix_f32 v162, v162, v26, v34 op_sel_hi:[1,0,0]
    v_fma_mix_f32 v170, v170, v26, v34 op_sel_hi:[1,0,0]
    v_fma_mix_f32 v178, v178, v26, v34 op_sel_hi:[1,0,0]
    v_cvt_pk_bf16_f32 v68, v154, v162
    v_cvt_pk_bf16_f32 v69, v170, v178
    ds_write_b64 v18, v[68:69] offset:6144
    v_fma_mix_f32 v155, v155, v27, v35 op_sel_hi:[1,0,0]
    v_fma_mix_f32 v163, v163, v27, v35 op_sel_hi:[1,0,0]
    v_fma_mix_f32 v171, v171, v27, v35 op_sel_hi:[1,0,0]
    v_fma_mix_f32 v179, v179, v27, v35 op_sel_hi:[1,0,0]
    v_cvt_pk_bf16_f32 v70, v155, v163
    v_cvt_pk_bf16_f32 v71, v171, v179
    ds_write_b64 v18, v[70:71] offset:7168
    v_fma_mix_f32 v180, v180, v36, v37 op_sel_hi:[1,0,0]
    v_fma_mix_f32 v181, v181, v36, v37 op_sel_hi:[1,0,0]
    v_fma_mix_f32 v182, v182, v36, v37 op_sel_hi:[1,0,0]
    v_fma_mix_f32 v183, v183, v36, v37 op_sel_hi:[1,0,0]
    v_cvt_pk_bf16_f32 v72, v180, v181
    v_cvt_pk_bf16_f32 v73, v182, v183
    ds_write_b64 v18, v[72:73] offset:8192
    s_waitcnt lgkmcnt(0)
    s_barrier
L_done:
    s_endpgm
.section .rodata,"a"
.p2align 6
.amdhsa_kernel standalone__weight_only_int_quip_2__prompt_kernel
  .amdhsa_next_free_vgpr 256
  .amdhsa_next_free_sgpr 72
  .amdhsa_accum_offset 256
  .amdhsa_group_segment_fixed_size 0
  .amdhsa_kernarg_size 56
  .amdhsa_user_sgpr_count 2
  .amdhsa_user_sgpr_kernarg_segment_ptr 1
  .amdhsa_system_sgpr_workgroup_id_x 1
  .amdhsa_float_denorm_mode_32 3
.end_amdhsa_kernel
```
